```python
import torch

def _softmax(x, axis=-1):
    return torch.softmax(x, dim=axis)
def _gelu(x):
    return torch.nn.functional.gelu(x, approximate="tanh")
def _silu(x):
    return torch.nn.functional.silu(x)
def _sigmoid(x):
    return torch.sigmoid(x)
def _layernorm(x, axis=-1, eps=1e-5):
    m = x.mean(dim=axis, keepdim=True)
    v = x.var(dim=axis, keepdim=True, unbiased=False)
    return (x - m) / torch.sqrt(v + eps)
def _scatter_add(tgt, idx, src, axis=0):
    return tgt.clone().index_add_(axis, idx, src)
def _segment_sum(src, seg, n):
    out = torch.zeros((n,) + src.shape[1:], dtype=src.dtype)
    return out.index_add_(0, seg, src)
def _pad(x, pw):
    flat = tuple(v for pair in reversed(pw) for v in pair)
    return torch.nn.functional.pad(x, flat)

kernel_name = 'recurrent_scan__mha_block_cached__glu_gated_reglu__decode'

def setup_inputs():

    _w = (lambda a: (lambda t: t.to(torch.bfloat16) if t.is_floating_point() else t)(torch.as_tensor(a)))
    def _A_setup():
        B, Sq, D = 1, 1, 640
        H, Sk, Dh = 32, 32768, 128
        return {
            "x": _w((lambda *s: torch.randn(*s, dtype=torch.bfloat16) * 0.4)(B, Sq, D)),
            "k_cache": _w((lambda *s: torch.randn(*s, dtype=torch.bfloat16) * 1.6)(B, H, Sk, Dh)),
            "v_cache": _w((lambda *s: torch.randn(*s, dtype=torch.bfloat16) * 1.6)(B, H, Sk, Dh)),
            "wq": _w((lambda *s: torch.randn(*s, dtype=torch.bfloat16) * 1.6)(D, H * Dh) * (D ** -0.5)),
            "wo": _w((lambda *s: torch.randn(*s, dtype=torch.bfloat16) * 1.6)(H * Dh, D) * ((H * Dh) ** -0.5)),
        }
    _A_in = _A_setup()

    def _B_setup():
        B, S, D, F = 1, 1, 640, 1728
        return {
            "x": _w((lambda *s: torch.randn(*s, dtype=torch.bfloat16) * 0.4)(B, S, D)),
            "W_gate": _w((lambda *s: torch.randn(*s, dtype=torch.bfloat16) * 1.6)(D, F) * (2.0 / D) ** 0.5),
            "W_up": _w((lambda *s: torch.randn(*s, dtype=torch.bfloat16) * 1.6)(D, F) * (2.0 / D) ** 0.5),
            "W_down": _w((lambda *s: torch.randn(*s, dtype=torch.bfloat16) * 1.6)(F, D) * (1.0 / F) ** 0.5),
        }
    _B_in = _B_setup()

    return {
        "A_x": _A_in["x"],
        "A_k_cache": _A_in["k_cache"],
        "A_v_cache": _A_in["v_cache"],
        "A_wq": _A_in["wq"],
        "A_wo": _A_in["wo"],
        "B_x": _B_in["x"],
        "B_W_gate": _B_in["W_gate"],
        "B_W_up": _B_in["W_up"],
        "B_W_down": _B_in["W_down"],
    }

def reference(A_x, A_k_cache, A_v_cache, A_wq, A_wo, B_x, B_W_gate, B_W_up, B_W_down):
    def _A_ref(x, k_cache, v_cache, wq, wo):
        B, Sq, D = x.shape
        H, Dh = 32, 128
        q = (lambda x, *d: x.permute(*d))((x @ wq).reshape(B, Sq, H, Dh), 0, 2, 1, 3)
        scores = torch.einsum("bhqd,bhkd->bhqk", q, k_cache) * (Dh ** -0.5)
        p = _softmax(scores, axis=-1)
        o = torch.einsum("bhqk,bhkd->bhqd", p, v_cache)
        return (lambda x, *d: x.permute(*d))(o, 0, 2, 1, 3).reshape(B, Sq, H * Dh) @ wo

    def _B_ref(x, W_gate, W_up, W_down):
        gate = torch.einsum("bsd,df->bsf", x, W_gate)
        up = torch.einsum("bsd,df->bsf", x, W_up)
        gate = gate * (lambda x, dt: x.to(dt))(gate > 0, gate.dtype)
        h = gate * up
        return torch.einsum("bsf,fd->bsd", h, W_down)

    x = A_x
    xn = _layernorm(x, axis=-1)
    s = _A_ref(xn, A_k_cache, A_v_cache, A_wq, A_wo)
    g = _silu(_B_ref(xn, B_W_gate, B_W_up, B_W_down))
    return x + s * g
```

```asm
; @launch grid=(256,1,1) block=(512,1,1) lds=41344
.amdgcn_target "amdgcn-amd-amdhsa--gfx950"
.text
.globl recurrent_scan__mha_block_cached__glu_gated_reglu__decode_kernel
.p2align 8
.type recurrent_scan__mha_block_cached__glu_gated_reglu__decode_kernel,@function
recurrent_scan__mha_block_cached__glu_gated_reglu__decode_kernel:
    s_cmp_ge_u32 s2, 256
    s_cbranch_scc1 L_done
    s_load_dwordx16 s[4:19], s[0:1], 0
    s_load_dwordx8 s[20:27], s[0:1], 64
    s_memrealtime s[86:87]
    v_lshrrev_b32 v1, 6, v0
    v_and_b32 v0, 63, v0
    s_and_b32 s41, s2, 7
    s_lshl_b32 s41, s41, 2
    s_lshr_b32 s42, s2, 6
    s_add_u32 s41, s41, s42
    s_bfe_u32 s42, s2, 0x30003
    v_readfirstlane_b32 s40, v1
    s_mov_b32 s31, 0x20000
    s_mov_b32 s35, 0x20000
    s_mov_b32 s39, 0x20000
    v_mov_b32 v2, 0
    v_mov_b32 v3, 0
    v_mov_b32 v4, 12800
    ds_write_b64 v4, v[2:3]
    s_cmp_ge_u32 s40, 4
    s_cbranch_scc1 L_aux
    v_lshlrev_b32 v44, 4, v0
    s_lshl_b32 s67, s41, 5
    s_lshl_b32 s43, s42, 2
    s_add_u32 s67, s67, s43
    s_add_u32 s67, s67, s40
    s_mul_i32 s45, s67, 5120
    s_mul_i32 s66, s67, 2560
    s_mov_b32 s30, 5242880
    s_mov_b32 s34, 2211840
    s_waitcnt lgkmcnt(0)
    s_mov_b32 s28, s12
    s_mov_b32 s29, s13
    s_mov_b32 s32, s20
    s_mov_b32 s33, s21
    s_barrier
    buffer_load_dwordx4 v[64:67], v44, s[28:31], s45 offen offset:0
    buffer_load_dwordx4 v[68:71], v44, s[28:31], s45 offen offset:1024
    buffer_load_dwordx4 v[72:75], v44, s[28:31], s45 offen offset:2048
    buffer_load_dwordx4 v[76:79], v44, s[28:31], s45 offen offset:3072
    s_add_u32 s45, s45, 4096
    buffer_load_dwordx4 v[80:83], v44, s[28:31], s45 offen offset:0
    buffer_load_dwordx4 v[84:87], v44, s[32:35], s66 offen offset:0
    buffer_load_dwordx4 v[88:91], v44, s[32:35], s66 offen offset:1024
    s_mov_b32 exec_hi, 0
    buffer_load_dwordx4 v[92:95], v44, s[32:35], s66 offen offset:2048
    s_mov_b64 exec, -1
    s_and_b32 s43, s41, 1
    s_lshl_b32 s43, s43, 2
    s_xor_b32 s43, s43, s40
    s_lshl_b32 s43, s43, 12
    v_add_u32 v8, s43, v44
    v_xor_b32 v9, 16384, v8
    v_xor_b32 v10, 32768, v8
    v_xor_b32 v11, 49152, v8
    s_and_b32 s44, s42, 1
    s_lshl_b32 s44, s44, 16
    s_lshr_b32 s43, s42, 1
    s_lshl_b32 s43, s43, 21
    s_or_b32 s44, s44, s43
    s_lshr_b32 s43, s42, 2
    s_lshl_b32 s43, s43, 18
    s_or_b32 s44, s44, s43
    s_lshl_b32 s43, s41, 23
    s_xor_b32 s48, s44, 0x20000
    s_add_u32 s28, s6, s43
    s_addc_u32 s29, s7, 0
    s_mov_b32 s30, 0x800000
    s_mov_b32 s32, s28
    s_mov_b32 s33, s29
    s_mov_b32 s34, 0x800000
    s_add_u32 s46, s8, s43
    s_addc_u32 s47, s9, 0
    v_and_b32 v1, 1, v0
    v_lshlrev_b32 v1, 4, v1
    v_mov_b32 v2, 0xffff
    v_lshlrev_b32 v2, v1, v2
    v_bfe_u32 v1, v0, 1, 2
    v_cmp_eq_u32 vcc, 0, v1
    s_nop 1
    v_cndmask_b32 v4, 0, v2, vcc
    v_cmp_eq_u32 vcc, 1, v1
    s_nop 1
    v_cndmask_b32 v5, 0, v2, vcc
    v_cmp_eq_u32 vcc, 2, v1
    s_nop 1
    v_cndmask_b32 v6, 0, v2, vcc
    v_cmp_eq_u32 vcc, 3, v1
    s_nop 1
    v_cndmask_b32 v7, 0, v2, vcc
    s_mov_b32 s52, 0x11111111
    s_mov_b32 s53, 0x11111111
    s_mov_b32 s54, 0x22222222
    s_mov_b32 s55, 0x22222222
    s_mov_b32 s56, 0x44444444
    s_mov_b32 s57, 0x44444444
    s_mov_b32 s58, 0x88888888
    s_mov_b32 s59, 0x88888888
    s_mov_b32 s60, 0x3db504f3
    s_mov_b32 s61, 0x3fb8aa3b
    v_mov_b32 v23, 0xff800000
    s_lshl_b32 s43, s40, 12
    s_add_u32 s43, s43, 14208
    v_lshlrev_b32 v24, 2, v0
    v_add_u32 v24, s43, v24
    v_mov_b32 v27, v24
    v_and_b32 v25, 15, v0
    v_lshlrev_b32 v25, 5, v25
    s_add_u32 s86, s86, 900
    s_lshl_b32 s86, s86, 4
    s_mov_b32 s51, 14
    s_mov_b32 s50, 16
    s_mov_b32 s36, s26
    s_mov_b32 s37, s27
    s_mov_b32 s38, 1294592
    s_lshr_b32 s65, s41, 2
    s_lshl_b32 s65, s65, 6
    s_add_u32 s65, s65, 1279232
    s_and_b32 s43, s41, 3
    s_lshl_b32 s43, s43, 5
    s_lshl_b32 s45, s42, 2
    s_add_u32 s43, s43, s45
    s_add_u32 s43, s43, s40
    s_cmp_eq_u32 s43, 56
    s_cselect_b32 s65, s65, 0
    s_add_u32 s70, s26, 1278208
    s_addc_u32 s71, s27, 0
    s_waitcnt vmcnt(5)
    buffer_load_dwordx4 v[128:131], v8, s[28:31], s44 offen nt
    s_waitcnt vmcnt(5)
    buffer_load_dwordx4 v[132:135], v8, s[28:31], s44 offen offset:1024 nt
    s_waitcnt vmcnt(5)
    buffer_load_dwordx4 v[136:139], v8, s[28:31], s44 offen offset:2048 nt
    s_waitcnt vmcnt(5)
    buffer_load_dwordx4 v[140:143], v8, s[28:31], s44 offen offset:3072 nt
    s_waitcnt vmcnt(5)
    buffer_load_dwordx4 v[144:147], v9, s[28:31], s44 offen nt
    s_waitcnt vmcnt(5)
    buffer_load_dwordx4 v[148:151], v9, s[28:31], s44 offen offset:1024 nt
    s_waitcnt vmcnt(5)
    buffer_load_dwordx4 v[152:155], v9, s[28:31], s44 offen offset:2048 nt
    s_waitcnt vmcnt(5)
    buffer_load_dwordx4 v[156:159], v9, s[28:31], s44 offen offset:3072 nt
    s_waitcnt vmcnt(5)
    buffer_load_dwordx4 v[160:163], v10, s[28:31], s44 offen nt
    s_barrier
    s_waitcnt vmcnt(5)
    buffer_load_dwordx4 v[164:167], v10, s[28:31], s44 offen offset:1024 nt
    s_waitcnt vmcnt(5)
    buffer_load_dwordx4 v[168:171], v10, s[28:31], s44 offen offset:2048 nt
    s_waitcnt vmcnt(5)
    buffer_load_dwordx4 v[172:175], v10, s[28:31], s44 offen offset:3072 nt
    s_waitcnt vmcnt(5)
    buffer_load_dwordx4 v[176:179], v11, s[28:31], s44 offen nt
    s_waitcnt vmcnt(5)
    buffer_load_dwordx4 v[180:183], v11, s[28:31], s44 offen offset:1024 nt
    s_waitcnt vmcnt(5)
    buffer_load_dwordx4 v[184:187], v11, s[28:31], s44 offen offset:2048 nt
    s_waitcnt vmcnt(5)
    buffer_load_dwordx4 v[188:191], v11, s[28:31], s44 offen offset:3072 nt
    s_waitcnt vmcnt(5)
    buffer_load_dwordx4 v[192:195], v8, s[28:31], s48 offen nt
    s_waitcnt vmcnt(5)
    buffer_load_dwordx4 v[196:199], v8, s[28:31], s48 offen offset:1024 nt
    s_waitcnt vmcnt(5)
    buffer_load_dwordx4 v[200:203], v8, s[28:31], s48 offen offset:2048 nt
    s_waitcnt vmcnt(5)
    buffer_load_dwordx4 v[204:207], v8, s[28:31], s48 offen offset:3072 nt
    s_waitcnt vmcnt(5)
    buffer_load_dwordx4 v[208:211], v9, s[28:31], s48 offen nt
    s_waitcnt vmcnt(5)
    buffer_load_dwordx4 v[212:215], v9, s[28:31], s48 offen offset:1024 nt
    s_waitcnt vmcnt(5)
    buffer_load_dwordx4 v[216:219], v9, s[28:31], s48 offen offset:2048 nt
    s_waitcnt vmcnt(5)
    buffer_load_dwordx4 v[220:223], v9, s[28:31], s48 offen offset:3072 nt
    s_waitcnt vmcnt(5)
    buffer_load_dwordx4 v[224:227], v10, s[28:31], s48 offen nt
    s_waitcnt vmcnt(5)
    buffer_load_dwordx4 v[228:231], v10, s[28:31], s48 offen offset:1024 nt
    s_waitcnt vmcnt(5)
    buffer_load_dwordx4 v[232:235], v10, s[28:31], s48 offen offset:2048 nt
    s_waitcnt vmcnt(5)
    buffer_load_dwordx4 v[236:239], v10, s[28:31], s48 offen offset:3072 nt
    s_waitcnt vmcnt(5)
    buffer_load_dwordx4 v[240:243], v11, s[28:31], s48 offen nt
    s_waitcnt vmcnt(5)
    buffer_load_dwordx4 v[244:247], v11, s[28:31], s48 offen offset:1024 nt
    s_waitcnt vmcnt(5)
    buffer_load_dwordx4 v[248:251], v11, s[28:31], s48 offen offset:2048 nt
    s_waitcnt vmcnt(5)
    buffer_load_dwordx4 v[252:255], v11, s[28:31], s48 offen offset:3072 nt
    s_xor_b32 s48, s44, 0x40000
    s_mov_b32 s67, 0x60000
    s_xor_b32 s49, s44, s67
    s_mov_b64 vcc, 0
    s_barrier
    ds_read_b128 v[44:47], v25 offset:6656
    ds_read_b128 v[48:51], v25 offset:6672
    ds_read_b128 v[52:55], v25 offset:7168
    ds_read_b128 v[56:59], v25 offset:7184
    ds_read_b128 v[28:31], v25 offset:7680
    ds_read_b128 v[32:35], v25 offset:7696
    ds_read_b128 v[36:39], v25 offset:8192
    ds_read_b128 v[60:63], v25 offset:8208
    s_waitcnt vmcnt(5)
    buffer_load_dwordx4 v[64:67], v8, s[28:31], s48 offen nt
    s_waitcnt lgkmcnt(4)
    v_add_f32 v44, v44, v52
    v_add_f32 v45, v45, v53
    v_add_f32 v46, v46, v54
    v_add_f32 v47, v47, v55
    v_add_f32 v48, v48, v56
    v_add_f32 v49, v49, v57
    v_add_f32 v50, v50, v58
    v_add_f32 v51, v51, v59
    s_waitcnt lgkmcnt(0)
    v_add_f32 v28, v28, v36
    v_add_f32 v29, v29, v37
    v_add_f32 v30, v30, v38
    v_add_f32 v31, v31, v39
    v_add_f32 v32, v32, v60
    v_add_f32 v33, v33, v61
    v_add_f32 v34, v34, v62
    v_add_f32 v35, v35, v63
    v_add_f32 v44, v44, v28
    v_add_f32 v45, v45, v29
    v_add_f32 v46, v46, v30
    v_add_f32 v47, v47, v31
    v_add_f32 v48, v48, v32
    v_add_f32 v49, v49, v33
    v_add_f32 v50, v50, v34
    v_add_f32 v51, v51, v35
    v_cvt_pk_bf16_f32 v12, v44, v45
    v_cvt_pk_bf16_f32 v13, v46, v47
    v_cvt_pk_bf16_f32 v14, v48, v49
    v_cvt_pk_bf16_f32 v15, v50, v51
    v_mov_b32 v36, 0
    v_mov_b32 v37, 0
    v_mov_b32 v38, 0
    v_mov_b32 v39, 0
    v_lshlrev_b32 v46, 2, v0
    v_dot2_f32_bf16 v16, v128, v12, 0
    v_dot2_f32_bf16 v16, v129, v13, v16
    v_dot2_f32_bf16 v16, v130, v14, v16
    v_dot2_f32_bf16 v16, v131, v15, v16
    v_dot2_f32_bf16 v17, v132, v12, 0
    v_dot2_f32_bf16 v17, v133, v13, v17
    v_dot2_f32_bf16 v17, v134, v14, v17
    v_dot2_f32_bf16 v17, v135, v15, v17
    v_add_f32_dpp v18, v16, v16 row_ror:8 row_mask:0xf bank_mask:0x3
    v_dot2_f32_bf16 v16, v136, v12, 0
    v_dot2_f32_bf16 v16, v137, v13, v16
    v_dot2_f32_bf16 v16, v138, v14, v16
    v_dot2_f32_bf16 v16, v139, v15, v16
    v_add_f32_dpp v18, v17, v17 row_ror:8 row_mask:0xf bank_mask:0xc
    v_dot2_f32_bf16 v17, v140, v12, 0
    v_dot2_f32_bf16 v17, v141, v13, v17
    v_dot2_f32_bf16 v17, v142, v14, v17
    v_dot2_f32_bf16 v17, v143, v15, v17
    v_add_f32_dpp v19, v16, v16 row_ror:8 row_mask:0xf bank_mask:0x3
    v_add_f32_dpp v20, v18, v18 row_half_mirror row_mask:0xf bank_mask:0x5
    s_waitcnt vmcnt(5)
    buffer_load_dwordx4 v[68:71], v8, s[28:31], s48 offen offset:1024 nt
    v_dot2_f32_bf16 v16, v144, v12, 0
    v_dot2_f32_bf16 v16, v145, v13, v16
    v_dot2_f32_bf16 v16, v146, v14, v16
    v_dot2_f32_bf16 v16, v147, v15, v16
    v_add_f32_dpp v19, v17, v17 row_ror:8 row_mask:0xf bank_mask:0xc
    v_dot2_f32_bf16 v17, v148, v12, 0
    v_dot2_f32_bf16 v17, v149, v13, v17
    v_dot2_f32_bf16 v17, v150, v14, v17
    v_dot2_f32_bf16 v17, v151, v15, v17
    v_add_f32_dpp v18, v16, v16 row_ror:8 row_mask:0xf bank_mask:0x3
    v_add_f32_dpp v20, v19, v19 row_half_mirror row_mask:0xf bank_mask:0xa
    v_dot2_f32_bf16 v16, v152, v12, 0
    v_dot2_f32_bf16 v16, v153, v13, v16
    v_dot2_f32_bf16 v16, v154, v14, v16
    v_dot2_f32_bf16 v16, v155, v15, v16
    v_add_f32_dpp v18, v17, v17 row_ror:8 row_mask:0xf bank_mask:0xc
    v_add_f32_dpp v21, v20, v20 quad_perm:[1,0,3,2] row_mask:0xf bank_mask:0xf
    v_dot2_f32_bf16 v17, v156, v12, 0
    v_dot2_f32_bf16 v17, v157, v13, v17
    v_dot2_f32_bf16 v17, v158, v14, v17
    v_dot2_f32_bf16 v17, v159, v15, v17
    v_add_f32_dpp v19, v16, v16 row_ror:8 row_mask:0xf bank_mask:0x3
    v_add_f32_dpp v20, v18, v18 row_half_mirror row_mask:0xf bank_mask:0x5
    v_add_f32_dpp v21, v21, v21 quad_perm:[2,3,0,1] row_mask:0xf bank_mask:0xf
    s_waitcnt vmcnt(5)
    buffer_load_dwordx4 v[72:75], v8, s[28:31], s48 offen offset:2048 nt
    v_dot2_f32_bf16 v16, v160, v12, 0
    v_dot2_f32_bf16 v16, v161, v13, v16
    v_dot2_f32_bf16 v16, v162, v14, v16
    v_dot2_f32_bf16 v16, v163, v15, v16
    v_add_f32_dpp v19, v17, v17 row_ror:8 row_mask:0xf bank_mask:0xc
    v_cndmask_b32_e64 v22, v22, v21, s[52:53]
    v_dot2_f32_bf16 v17, v164, v12, 0
    v_dot2_f32_bf16 v17, v165, v13, v17
    v_dot2_f32_bf16 v17, v166, v14, v17
    v_dot2_f32_bf16 v17, v167, v15, v17
    v_add_f32_dpp v18, v16, v16 row_ror:8 row_mask:0xf bank_mask:0x3
    v_add_f32_dpp v20, v19, v19 row_half_mirror row_mask:0xf bank_mask:0xa
    v_dot2_f32_bf16 v16, v168, v12, 0
    v_dot2_f32_bf16 v16, v169, v13, v16
    v_dot2_f32_bf16 v16, v170, v14, v16
    v_dot2_f32_bf16 v16, v171, v15, v16
    v_add_f32_dpp v18, v17, v17 row_ror:8 row_mask:0xf bank_mask:0xc
    v_add_f32_dpp v21, v20, v20 quad_perm:[1,0,3,2] row_mask:0xf bank_mask:0xf
    v_dot2_f32_bf16 v17, v172, v12, 0
    v_dot2_f32_bf16 v17, v173, v13, v17
    v_dot2_f32_bf16 v17, v174, v14, v17
    v_dot2_f32_bf16 v17, v175, v15, v17
    v_add_f32_dpp v19, v16, v16 row_ror:8 row_mask:0xf bank_mask:0x3
    v_add_f32_dpp v20, v18, v18 row_half_mirror row_mask:0xf bank_mask:0x5
    v_add_f32_dpp v21, v21, v21 quad_perm:[2,3,0,1] row_mask:0xf bank_mask:0xf
    s_waitcnt vmcnt(5)
    buffer_load_dwordx4 v[76:79], v8, s[28:31], s48 offen offset:3072 nt
    v_dot2_f32_bf16 v16, v176, v12, 0
    v_dot2_f32_bf16 v16, v177, v13, v16
    v_dot2_f32_bf16 v16, v178, v14, v16
    v_dot2_f32_bf16 v16, v179, v15, v16
    v_add_f32_dpp v19, v17, v17 row_ror:8 row_mask:0xf bank_mask:0xc
    v_cndmask_b32_e64 v22, v22, v21, s[54:55]
    v_dot2_f32_bf16 v17, v180, v12, 0
    v_dot2_f32_bf16 v17, v181, v13, v17
    v_dot2_f32_bf16 v17, v182, v14, v17
    v_dot2_f32_bf16 v17, v183, v15, v17
    v_add_f32_dpp v18, v16, v16 row_ror:8 row_mask:0xf bank_mask:0x3
    v_add_f32_dpp v20, v19, v19 row_half_mirror row_mask:0xf bank_mask:0xa
    v_dot2_f32_bf16 v16, v184, v12, 0
    v_dot2_f32_bf16 v16, v185, v13, v16
    v_dot2_f32_bf16 v16, v186, v14, v16
    v_dot2_f32_bf16 v16, v187, v15, v16
    v_add_f32_dpp v18, v17, v17 row_ror:8 row_mask:0xf bank_mask:0xc
    v_add_f32_dpp v21, v20, v20 quad_perm:[1,0,3,2] row_mask:0xf bank_mask:0xf
    v_dot2_f32_bf16 v17, v188, v12, 0
    v_dot2_f32_bf16 v17, v189, v13, v17
    v_dot2_f32_bf16 v17, v190, v14, v17
    v_dot2_f32_bf16 v17, v191, v15, v17
    v_add_f32_dpp v19, v16, v16 row_ror:8 row_mask:0xf bank_mask:0x3
    v_add_f32_dpp v20, v18, v18 row_half_mirror row_mask:0xf bank_mask:0x5
    v_add_f32_dpp v21, v21, v21 quad_perm:[2,3,0,1] row_mask:0xf bank_mask:0xf
    s_waitcnt vmcnt(5)
    buffer_load_dwordx4 v[80:83], v9, s[28:31], s48 offen nt
    v_dot2_f32_bf16 v16, v192, v12, 0
    v_dot2_f32_bf16 v16, v193, v13, v16
    v_dot2_f32_bf16 v16, v194, v14, v16
    v_dot2_f32_bf16 v16, v195, v15, v16
    v_add_f32_dpp v19, v17, v17 row_ror:8 row_mask:0xf bank_mask:0xc
    v_cndmask_b32_e64 v22, v22, v21, s[56:57]
    v_dot2_f32_bf16 v17, v196, v12, 0
    v_dot2_f32_bf16 v17, v197, v13, v17
    v_dot2_f32_bf16 v17, v198, v14, v17
    v_dot2_f32_bf16 v17, v199, v15, v17
    v_add_f32_dpp v18, v16, v16 row_ror:8 row_mask:0xf bank_mask:0x3
    v_add_f32_dpp v20, v19, v19 row_half_mirror row_mask:0xf bank_mask:0xa
    v_dot2_f32_bf16 v16, v200, v12, 0
    v_dot2_f32_bf16 v16, v201, v13, v16
    v_dot2_f32_bf16 v16, v202, v14, v16
    v_dot2_f32_bf16 v16, v203, v15, v16
    v_add_f32_dpp v18, v17, v17 row_ror:8 row_mask:0xf bank_mask:0xc
    v_add_f32_dpp v21, v20, v20 quad_perm:[1,0,3,2] row_mask:0xf bank_mask:0xf
    v_dot2_f32_bf16 v17, v204, v12, 0
    v_dot2_f32_bf16 v17, v205, v13, v17
    v_dot2_f32_bf16 v17, v206, v14, v17
    v_dot2_f32_bf16 v17, v207, v15, v17
    v_add_f32_dpp v19, v16, v16 row_ror:8 row_mask:0xf bank_mask:0x3
    v_add_f32_dpp v20, v18, v18 row_half_mirror row_mask:0xf bank_mask:0x5
    v_add_f32_dpp v21, v21, v21 quad_perm:[2,3,0,1] row_mask:0xf bank_mask:0xf
    s_waitcnt vmcnt(5)
    buffer_load_dwordx4 v[84:87], v9, s[28:31], s48 offen offset:1024 nt
    v_dot2_f32_bf16 v16, v208, v12, 0
    v_dot2_f32_bf16 v16, v209, v13, v16
    v_dot2_f32_bf16 v16, v210, v14, v16
    v_dot2_f32_bf16 v16, v211, v15, v16
    v_add_f32_dpp v19, v17, v17 row_ror:8 row_mask:0xf bank_mask:0xc
    v_cndmask_b32_e64 v22, v22, v21, s[58:59]
    v_dot2_f32_bf16 v17, v212, v12, 0
    v_dot2_f32_bf16 v17, v213, v13, v17
    v_dot2_f32_bf16 v17, v214, v14, v17
    v_dot2_f32_bf16 v17, v215, v15, v17
    v_add_f32_dpp v18, v16, v16 row_ror:8 row_mask:0xf bank_mask:0x3
    v_add_f32_dpp v20, v19, v19 row_half_mirror row_mask:0xf bank_mask:0xa
    v_cvt_pk_bf16_f32 v26, v22, v22
    v_and_b32 v26, 0xffff0000, v26
    v_mul_f32 v26, s60, v26
    v_dot2_f32_bf16 v16, v216, v12, 0
    v_dot2_f32_bf16 v16, v217, v13, v16
    v_dot2_f32_bf16 v16, v218, v14, v16
    v_dot2_f32_bf16 v16, v219, v15, v16
    v_add_f32_dpp v18, v17, v17 row_ror:8 row_mask:0xf bank_mask:0xc
    v_add_f32_dpp v21, v20, v20 quad_perm:[1,0,3,2] row_mask:0xf bank_mask:0xf
    v_cvt_pk_bf16_f32 v26, v26, v26
    v_and_b32 v26, 0xffff0000, v26
    v_dot2_f32_bf16 v17, v220, v12, 0
    v_dot2_f32_bf16 v17, v221, v13, v17
    v_dot2_f32_bf16 v17, v222, v14, v17
    v_dot2_f32_bf16 v17, v223, v15, v17
    v_add_f32_dpp v19, v16, v16 row_ror:8 row_mask:0xf bank_mask:0x3
    v_add_f32_dpp v20, v18, v18 row_half_mirror row_mask:0xf bank_mask:0x5
    v_add_f32_dpp v21, v21, v21 quad_perm:[2,3,0,1] row_mask:0xf bank_mask:0xf
    v_max_f32 v23, v23, v26
    ds_write_b32 v24, v26
    v_add_u32 v24, 256, v24
    s_waitcnt vmcnt(5)
    buffer_load_dwordx4 v[88:91], v9, s[28:31], s48 offen offset:2048 nt
    v_dot2_f32_bf16 v16, v224, v12, 0
    v_dot2_f32_bf16 v16, v225, v13, v16
    v_dot2_f32_bf16 v16, v226, v14, v16
    v_dot2_f32_bf16 v16, v227, v15, v16
    v_add_f32_dpp v19, v17, v17 row_ror:8 row_mask:0xf bank_mask:0xc
    v_cndmask_b32_e64 v22, v22, v21, s[52:53]
    v_dot2_f32_bf16 v17, v228, v12, 0
    v_dot2_f32_bf16 v17, v229, v13, v17
    v_dot2_f32_bf16 v17, v230, v14, v17
    v_dot2_f32_bf16 v17, v231, v15, v17
    v_add_f32_dpp v18, v16, v16 row_ror:8 row_mask:0xf bank_mask:0x3
    v_add_f32_dpp v20, v19, v19 row_half_mirror row_mask:0xf bank_mask:0xa
    v_dot2_f32_bf16 v16, v232, v12, 0
    v_dot2_f32_bf16 v16, v233, v13, v16
    v_dot2_f32_bf16 v16, v234, v14, v16
    v_dot2_f32_bf16 v16, v235, v15, v16
    v_add_f32_dpp v18, v17, v17 row_ror:8 row_mask:0xf bank_mask:0xc
    v_add_f32_dpp v21, v20, v20 quad_perm:[1,0,3,2] row_mask:0xf bank_mask:0xf
    v_dot2_f32_bf16 v17, v236, v12, 0
    v_dot2_f32_bf16 v17, v237, v13, v17
    v_dot2_f32_bf16 v17, v238, v14, v17
    v_dot2_f32_bf16 v17, v239, v15, v17
    v_add_f32_dpp v19, v16, v16 row_ror:8 row_mask:0xf bank_mask:0x3
    v_add_f32_dpp v20, v18, v18 row_half_mirror row_mask:0xf bank_mask:0x5
    v_add_f32_dpp v21, v21, v21 quad_perm:[2,3,0,1] row_mask:0xf bank_mask:0xf
    s_waitcnt vmcnt(5)
    buffer_load_dwordx4 v[92:95], v9, s[28:31], s48 offen offset:3072 nt
    v_dot2_f32_bf16 v16, v240, v12, 0
    v_dot2_f32_bf16 v16, v241, v13, v16
    v_dot2_f32_bf16 v16, v242, v14, v16
    v_dot2_f32_bf16 v16, v243, v15, v16
    v_add_f32_dpp v19, v17, v17 row_ror:8 row_mask:0xf bank_mask:0xc
    v_cndmask_b32_e64 v22, v22, v21, s[54:55]
    v_dot2_f32_bf16 v17, v244, v12, 0
    v_dot2_f32_bf16 v17, v245, v13, v17
    v_dot2_f32_bf16 v17, v246, v14, v17
    v_dot2_f32_bf16 v17, v247, v15, v17
    v_add_f32_dpp v18, v16, v16 row_ror:8 row_mask:0xf bank_mask:0x3
    v_add_f32_dpp v20, v19, v19 row_half_mirror row_mask:0xf bank_mask:0xa
    v_dot2_f32_bf16 v16, v248, v12, 0
    v_dot2_f32_bf16 v16, v249, v13, v16
    v_dot2_f32_bf16 v16, v250, v14, v16
    v_dot2_f32_bf16 v16, v251, v15, v16
    v_add_f32_dpp v18, v17, v17 row_ror:8 row_mask:0xf bank_mask:0xc
    v_add_f32_dpp v21, v20, v20 quad_perm:[1,0,3,2] row_mask:0xf bank_mask:0xf
    v_dot2_f32_bf16 v17, v252, v12, 0
    v_dot2_f32_bf16 v17, v253, v13, v17
    v_dot2_f32_bf16 v17, v254, v14, v17
    v_dot2_f32_bf16 v17, v255, v15, v17
    v_add_f32_dpp v19, v16, v16 row_ror:8 row_mask:0xf bank_mask:0x3
    v_add_f32_dpp v20, v18, v18 row_half_mirror row_mask:0xf bank_mask:0x5
    v_add_f32_dpp v21, v21, v21 quad_perm:[2,3,0,1] row_mask:0xf bank_mask:0xf
.p2align 3
L_kloop:
    s_cmp_eq_u32 s51, 1
    s_cselect_b32 s32, s46, s32
    s_cselect_b32 s33, s47, s33
    s_cselect_b32 s49, s44, s49
    s_waitcnt vmcnt(6)
    s_cbranch_vccnz L_th1
    s_waitcnt vmcnt(4)
L_th1:
    buffer_load_dwordx4 v[96:99], v10, s[28:31], s48 offen nt
    v_dot2_f32_bf16 v16, v64, v12, 0
    v_dot2_f32_bf16 v16, v65, v13, v16
    v_dot2_f32_bf16 v16, v66, v14, v16
    v_dot2_f32_bf16 v16, v67, v15, v16
    v_add_f32_dpp v19, v17, v17 row_ror:8 row_mask:0xf bank_mask:0xc
    v_cndmask_b32_e64 v22, v22, v21, s[56:57]
    s_waitcnt vmcnt(6)
    s_cbranch_vccnz L_th2
    s_waitcnt vmcnt(4)
L_th2:
    buffer_load_dwordx4 v[100:103], v10, s[28:31], s48 offen offset:1024 nt
    v_dot2_f32_bf16 v17, v68, v12, 0
    v_dot2_f32_bf16 v17, v69, v13, v17
    v_dot2_f32_bf16 v17, v70, v14, v17
    v_dot2_f32_bf16 v17, v71, v15, v17
    v_add_f32_dpp v18, v16, v16 row_ror:8 row_mask:0xf bank_mask:0x3
    v_add_f32_dpp v20, v19, v19 row_half_mirror row_mask:0xf bank_mask:0xa
    s_memrealtime s[88:89]
    s_waitcnt vmcnt(6)
    s_cbranch_vccnz L_th3
    s_waitcnt vmcnt(4)
L_th3:
    buffer_load_dwordx4 v[104:107], v10, s[28:31], s48 offen offset:2048 nt
    v_dot2_f32_bf16 v16, v72, v12, 0
    v_dot2_f32_bf16 v16, v73, v13, v16
    v_dot2_f32_bf16 v16, v74, v14, v16
    v_dot2_f32_bf16 v16, v75, v15, v16
    v_add_f32_dpp v18, v17, v17 row_ror:8 row_mask:0xf bank_mask:0xc
    v_add_f32_dpp v21, v20, v20 quad_perm:[1,0,3,2] row_mask:0xf bank_mask:0xf
    s_waitcnt vmcnt(6)
    s_cbranch_vccnz L_th4
    s_waitcnt vmcnt(4)
L_th4:
    buffer_load_dwordx4 v[108:111], v10, s[28:31], s48 offen offset:3072 nt
    v_dot2_f32_bf16 v17, v76, v12, 0
    v_dot2_f32_bf16 v17, v77, v13, v17
    v_dot2_f32_bf16 v17, v78, v14, v17
    v_dot2_f32_bf16 v17, v79, v15, v17
    v_add_f32_dpp v19, v16, v16 row_ror:8 row_mask:0xf bank_mask:0x3
    v_add_f32_dpp v20, v18, v18 row_half_mirror row_mask:0xf bank_mask:0x5
    v_add_f32_dpp v21, v21, v21 quad_perm:[2,3,0,1] row_mask:0xf bank_mask:0xf
    s_waitcnt lgkmcnt(0)
    s_lshl_b32 s89, s88, 4
    s_sub_u32 s87, s89, s86
    s_add_u32 s86, s86, 1704
    s_cmp_gt_i32 s87, 0
    s_cselect_b64 vcc, -1, 0
    s_cmp_eq_u32 s65, 0
    s_cbranch_scc1 L_nr5
    v_mov_b32 v45, s88
    s_mov_b64 exec, 0xffff
    buffer_store_dword v45, v46, s[36:39], s65 offen sc1
    s_mov_b64 exec, -1
    s_add_u32 s65, s65, 512
L_nr5:
    s_waitcnt vmcnt(6)
    s_cbranch_vccnz L_th6
    s_waitcnt vmcnt(4)
L_th6:
    buffer_load_dwordx4 v[112:115], v11, s[28:31], s48 offen nt
    v_dot2_f32_bf16 v16, v80, v12, 0
    v_dot2_f32_bf16 v16, v81, v13, v16
    v_dot2_f32_bf16 v16, v82, v14, v16
    v_dot2_f32_bf16 v16, v83, v15, v16
    v_add_f32_dpp v19, v17, v17 row_ror:8 row_mask:0xf bank_mask:0xc
    v_cndmask_b32_e64 v22, v22, v21, s[58:59]
    s_waitcnt vmcnt(6)
    s_cbranch_vccnz L_th7
    s_waitcnt vmcnt(4)
L_th7:
    buffer_load_dwordx4 v[116:119], v11, s[28:31], s48 offen offset:1024 nt
    v_dot2_f32_bf16 v17, v84, v12, 0
    v_dot2_f32_bf16 v17, v85, v13, v17
    v_dot2_f32_bf16 v17, v86, v14, v17
    v_dot2_f32_bf16 v17, v87, v15, v17
    v_add_f32_dpp v18, v16, v16 row_ror:8 row_mask:0xf bank_mask:0x3
    v_add_f32_dpp v20, v19, v19 row_half_mirror row_mask:0xf bank_mask:0xa
    v_cvt_pk_bf16_f32 v26, v22, v22
    v_and_b32 v26, 0xffff0000, v26
    v_mul_f32 v26, s60, v26
    s_load_dword s72, s[70:71], 0
    s_load_dword s73, s[70:71], 64
    s_load_dword s74, s[70:71], 128
    s_load_dword s75, s[70:71], 192
    s_load_dword s76, s[70:71], 256
    s_load_dword s77, s[70:71], 320
    s_load_dword s78, s[70:71], 384
    s_load_dword s79, s[70:71], 448
    s_add_u32 s70, s70, 512
    s_addc_u32 s71, s71, 0
    s_waitcnt vmcnt(6)
    s_cbranch_vccnz L_th8
    s_waitcnt vmcnt(4)
L_th8:
    buffer_load_dwordx4 v[120:123], v11, s[28:31], s48 offen offset:2048 nt
    v_dot2_f32_bf16 v16, v88, v12, 0
    v_dot2_f32_bf16 v16, v89, v13, v16
    v_dot2_f32_bf16 v16, v90, v14, v16
    v_dot2_f32_bf16 v16, v91, v15, v16
    v_add_f32_dpp v18, v17, v17 row_ror:8 row_mask:0xf bank_mask:0xc
    v_add_f32_dpp v21, v20, v20 quad_perm:[1,0,3,2] row_mask:0xf bank_mask:0xf
    v_cvt_pk_bf16_f32 v26, v26, v26
    v_and_b32 v26, 0xffff0000, v26
    s_waitcnt vmcnt(6)
    s_cbranch_vccnz L_th9
    s_waitcnt vmcnt(4)
L_th9:
    buffer_load_dwordx4 v[124:127], v11, s[28:31], s48 offen offset:3072 nt
    v_dot2_f32_bf16 v17, v92, v12, 0
    v_dot2_f32_bf16 v17, v93, v13, v17
    v_dot2_f32_bf16 v17, v94, v14, v17
    v_dot2_f32_bf16 v17, v95, v15, v17
    v_add_f32_dpp v19, v16, v16 row_ror:8 row_mask:0xf bank_mask:0x3
    v_add_f32_dpp v20, v18, v18 row_half_mirror row_mask:0xf bank_mask:0x5
    v_add_f32_dpp v21, v21, v21 quad_perm:[2,3,0,1] row_mask:0xf bank_mask:0xf
    v_max_f32 v23, v23, v26
    ds_write_b32 v24, v26
    v_add_u32 v24, 256, v24
    s_waitcnt vmcnt(6)
    s_cbranch_vccnz L_th10
    s_waitcnt vmcnt(4)
L_th10:
    buffer_load_dwordx4 v[64:67], v8, s[32:35], s49 offen nt
    v_dot2_f32_bf16 v16, v96, v12, 0
    v_dot2_f32_bf16 v16, v97, v13, v16
    v_dot2_f32_bf16 v16, v98, v14, v16
    v_dot2_f32_bf16 v16, v99, v15, v16
    v_add_f32_dpp v19, v17, v17 row_ror:8 row_mask:0xf bank_mask:0xc
    v_cndmask_b32_e64 v22, v22, v21, s[52:53]
    s_waitcnt vmcnt(6)
    s_cbranch_vccnz L_th11
    s_waitcnt vmcnt(4)
L_th11:
    buffer_load_dwordx4 v[68:71], v8, s[32:35], s49 offen offset:1024 nt
    v_dot2_f32_bf16 v17, v100, v12, 0
    v_dot2_f32_bf16 v17, v101, v13, v17
    v_dot2_f32_bf16 v17, v102, v14, v17
    v_dot2_f32_bf16 v17, v103, v15, v17
    v_add_f32_dpp v18, v16, v16 row_ror:8 row_mask:0xf bank_mask:0x3
    v_add_f32_dpp v20, v19, v19 row_half_mirror row_mask:0xf bank_mask:0xa
    s_memrealtime s[88:89]
    s_waitcnt vmcnt(6)
    s_cbranch_vccnz L_th12
    s_waitcnt vmcnt(4)
L_th12:
    buffer_load_dwordx4 v[72:75], v8, s[32:35], s49 offen offset:2048 nt
    v_dot2_f32_bf16 v16, v104, v12, 0
    v_dot2_f32_bf16 v16, v105, v13, v16
    v_dot2_f32_bf16 v16, v106, v14, v16
    v_dot2_f32_bf16 v16, v107, v15, v16
    v_add_f32_dpp v18, v17, v17 row_ror:8 row_mask:0xf bank_mask:0xc
    v_add_f32_dpp v21, v20, v20 quad_perm:[1,0,3,2] row_mask:0xf bank_mask:0xf
    s_waitcnt vmcnt(6)
    s_cbranch_vccnz L_th13
    s_waitcnt vmcnt(4)
L_th13:
    buffer_load_dwordx4 v[76:79], v8, s[32:35], s49 offen offset:3072 nt
    v_dot2_f32_bf16 v17, v108, v12, 0
    v_dot2_f32_bf16 v17, v109, v13, v17
    v_dot2_f32_bf16 v17, v110, v14, v17
    v_dot2_f32_bf16 v17, v111, v15, v17
    v_add_f32_dpp v19, v16, v16 row_ror:8 row_mask:0xf bank_mask:0x3
    v_add_f32_dpp v20, v18, v18 row_half_mirror row_mask:0xf bank_mask:0x5
    v_add_f32_dpp v21, v21, v21 quad_perm:[2,3,0,1] row_mask:0xf bank_mask:0xf
    s_waitcnt lgkmcnt(0)
    s_lshl_b32 s89, s88, 4
    s_sub_u32 s87, s89, s86
    s_add_u32 s86, s86, 1704
    s_cmp_gt_i32 s87, 0
    s_cselect_b64 vcc, -1, 0
    s_sub_u32 s72, s88, s72
    s_sub_u32 s73, s88, s73
    s_sub_u32 s74, s88, s74
    s_sub_u32 s75, s88, s75
    s_sub_u32 s76, s88, s76
    s_sub_u32 s77, s88, s77
    s_sub_u32 s78, s88, s78
    s_sub_u32 s79, s88, s79
    s_max_u32 s80, s72, s73
    s_add_u32 s81, s72, s73
    s_max_u32 s80, s80, s74
    s_add_u32 s81, s81, s74
    s_max_u32 s80, s80, s75
    s_add_u32 s81, s81, s75
    s_max_u32 s80, s80, s76
    s_add_u32 s81, s81, s76
    s_max_u32 s80, s80, s77
    s_add_u32 s81, s81, s77
    s_max_u32 s80, s80, s78
    s_add_u32 s81, s81, s78
    s_max_u32 s80, s80, s79
    s_add_u32 s81, s81, s79
    s_lshl_b32 s81, s81, 1
    s_sub_u32 s81, s89, s81
    s_add_u32 s81, s81, 10384
    s_cmp_lt_u32 s80, 1500
    s_cselect_b32 s86, s81, s86
    s_waitcnt vmcnt(6)
    s_cbranch_vccnz L_th14
    s_waitcnt vmcnt(4)
L_th14:
    buffer_load_dwordx4 v[80:83], v9, s[32:35], s49 offen nt
    v_dot2_f32_bf16 v16, v112, v12, 0
    v_dot2_f32_bf16 v16, v113, v13, v16
    v_dot2_f32_bf16 v16, v114, v14, v16
    v_dot2_f32_bf16 v16, v115, v15, v16
    v_add_f32_dpp v19, v17, v17 row_ror:8 row_mask:0xf bank_mask:0xc
    v_cndmask_b32_e64 v22, v22, v21, s[54:55]
    s_waitcnt vmcnt(6)
    s_cbranch_vccnz L_th15
    s_waitcnt vmcnt(4)
L_th15:
    buffer_load_dwordx4 v[84:87], v9, s[32:35], s49 offen offset:1024 nt
    v_dot2_f32_bf16 v17, v116, v12, 0
    v_dot2_f32_bf16 v17, v117, v13, v17
    v_dot2_f32_bf16 v17, v118, v14, v17
    v_dot2_f32_bf16 v17, v119, v15, v17
    v_add_f32_dpp v18, v16, v16 row_ror:8 row_mask:0xf bank_mask:0x3
    v_add_f32_dpp v20, v19, v19 row_half_mirror row_mask:0xf bank_mask:0xa
    s_waitcnt vmcnt(6)
    s_cbranch_vccnz L_th16
    s_waitcnt vmcnt(4)
L_th16:
    buffer_load_dwordx4 v[88:91], v9, s[32:35], s49 offen offset:2048 nt
    v_dot2_f32_bf16 v16, v120, v12, 0
    v_dot2_f32_bf16 v16, v121, v13, v16
    v_dot2_f32_bf16 v16, v122, v14, v16
    v_dot2_f32_bf16 v16, v123, v15, v16
    v_add_f32_dpp v18, v17, v17 row_ror:8 row_mask:0xf bank_mask:0xc
    v_add_f32_dpp v21, v20, v20 quad_perm:[1,0,3,2] row_mask:0xf bank_mask:0xf
    s_waitcnt vmcnt(6)
    s_cbranch_vccnz L_th17
    s_waitcnt vmcnt(4)
L_th17:
    buffer_load_dwordx4 v[92:95], v9, s[32:35], s49 offen offset:3072 nt
    v_dot2_f32_bf16 v17, v124, v12, 0
    v_dot2_f32_bf16 v17, v125, v13, v17
    v_dot2_f32_bf16 v17, v126, v14, v17
    v_dot2_f32_bf16 v17, v127, v15, v17
    v_add_f32_dpp v19, v16, v16 row_ror:8 row_mask:0xf bank_mask:0x3
    v_add_f32_dpp v20, v18, v18 row_half_mirror row_mask:0xf bank_mask:0x5
    v_add_f32_dpp v21, v21, v21 quad_perm:[2,3,0,1] row_mask:0xf bank_mask:0xf
    s_mov_b32 s48, s49
    s_add_u32 s67, s67, 0x20000
    s_xor_b32 s49, s44, s67
    s_sub_u32 s51, s51, 1
    s_cmp_lg_u32 s51, 0
    s_cbranch_scc1 L_kloop
    ds_read_b32 v42, v27
    s_nop 2
    v_add_f32_dpp v19, v17, v17 row_ror:8 row_mask:0xf bank_mask:0xc
    v_cndmask_b32_e64 v22, v22, v21, s[56:57]
    s_nop 2
    v_add_f32_dpp v20, v19, v19 row_half_mirror row_mask:0xf bank_mask:0xa
    s_nop 2
    v_add_f32_dpp v21, v20, v20 quad_perm:[1,0,3,2] row_mask:0xf bank_mask:0xf
    s_nop 2
    v_add_f32_dpp v21, v21, v21 quad_perm:[2,3,0,1] row_mask:0xf bank_mask:0xf
    s_nop 2
    v_cndmask_b32_e64 v22, v22, v21, s[58:59]
    s_nop 2
    v_cvt_pk_bf16_f32 v26, v22, v22
    v_and_b32 v26, 0xffff0000, v26
    v_mul_f32 v26, s60, v26
    s_nop 2
    v_cvt_pk_bf16_f32 v26, v26, v26
    v_and_b32 v26, 0xffff0000, v26
    s_nop 2
    v_max_f32 v23, v23, v26
    ds_write_b32 v24, v26
    v_add_u32 v24, 256, v24
    s_nop 1
    v_max_f32_dpp v23, v23, v23 quad_perm:[1,0,3,2] row_mask:0xf bank_mask:0xf
    s_nop 1
    v_max_f32_dpp v23, v23, v23 quad_perm:[2,3,0,1] row_mask:0xf bank_mask:0xf
    s_nop 1
    v_max_f32_dpp v23, v23, v23 row_half_mirror row_mask:0xf bank_mask:0xf
    s_nop 1
    v_max_f32_dpp v23, v23, v23 row_ror:8 row_mask:0xf bank_mask:0xf
    v_mov_b32 v25, v23
    s_nop 1
    v_permlane16_swap_b32 v25, v23
    v_max_f32 v23, v23, v25
    v_mov_b32 v25, v23
    s_nop 1
    v_permlane32_swap_b32 v25, v23
    v_max_f32 v23, v23, v25
    s_lshl_b32 s43, s40, 2
    s_add_u32 s43, s43, 12816
    v_mov_b32 v25, s43
    ds_write_b32 v25, v23
    v_mov_b32 v25, 12804
    v_mov_b32 v26, 1
    v_mul_f32 v43, s61, v23
    s_waitcnt lgkmcnt(0)
    s_mov_b64 exec, 1
    ds_add_u32 v25, v26
    s_mov_b64 exec, -1
    v_fma_f32 v42, v42, s61, -v43
    v_exp_f32 v42, v42
    s_nop 0
    v_cvt_pk_bf16_f32 v40, v42, v42
    v_lshrrev_b32 v25, 4, v0
    v_lshlrev_b32 v25, 7, v25
    v_and_b32 v26, 7, v0
    v_lshl_add_u32 v25, v26, 2, v25
    s_lshl_b32 s43, s40, 9
    s_add_u32 s43, s43, 10752
    v_add_u32 v25, s43, v25
    v_and_b32_dpp v28, v40, v4 row_newbcast:0 row_mask:0xf bank_mask:0xf
    v_and_b32_dpp v29, v40, v5 row_newbcast:0 row_mask:0xf bank_mask:0xf
    v_and_b32_dpp v30, v40, v6 row_newbcast:0 row_mask:0xf bank_mask:0xf
    v_and_b32_dpp v31, v40, v7 row_newbcast:0 row_mask:0xf bank_mask:0xf
    s_mov_b32 s67, 0x20000
    s_add_u32 s86, s86, 0
.p2align 3
L_vloop:
    s_xor_b32 s49, s44, s67
    s_cmp_eq_u32 s50, 1
    s_cselect_b32 s49, 0x1000000, s49
    s_waitcnt vmcnt(6)
    s_cbranch_vccnz L_th18
    s_waitcnt vmcnt(4)
L_th18:
    buffer_load_dwordx4 v[96:99], v10, s[32:35], s48 offen nt
    v_mfma_f32_16x16x32_bf16 v[36:39], v[64:67], v[28:31], v[36:39]
    v_and_b32_dpp v32, v40, v4 row_newbcast:8 row_mask:0xf bank_mask:0xf
    v_and_b32_dpp v33, v40, v5 row_newbcast:8 row_mask:0xf bank_mask:0xf
    v_and_b32_dpp v34, v40, v6 row_newbcast:8 row_mask:0xf bank_mask:0xf
    v_and_b32_dpp v35, v40, v7 row_newbcast:8 row_mask:0xf bank_mask:0xf
    s_waitcnt vmcnt(6)
    s_cbranch_vccnz L_th19
    s_waitcnt vmcnt(4)
L_th19:
    buffer_load_dwordx4 v[100:103], v10, s[32:35], s48 offen offset:1024 nt
    v_mfma_f32_16x16x32_bf16 v[36:39], v[68:71], v[32:35], v[36:39]
    v_and_b32_dpp v28, v40, v4 row_newbcast:4 row_mask:0xf bank_mask:0xf
    v_and_b32_dpp v29, v40, v5 row_newbcast:4 row_mask:0xf bank_mask:0xf
    v_and_b32_dpp v30, v40, v6 row_newbcast:4 row_mask:0xf bank_mask:0xf
    v_and_b32_dpp v31, v40, v7 row_newbcast:4 row_mask:0xf bank_mask:0xf
    s_memrealtime s[88:89]
    s_waitcnt vmcnt(6)
    s_cbranch_vccnz L_th20
    s_waitcnt vmcnt(4)
L_th20:
    buffer_load_dwordx4 v[104:107], v10, s[32:35], s48 offen offset:2048 nt
    v_mfma_f32_16x16x32_bf16 v[36:39], v[72:75], v[28:31], v[36:39]
    v_and_b32_dpp v32, v40, v4 row_newbcast:12 row_mask:0xf bank_mask:0xf
    v_and_b32_dpp v33, v40, v5 row_newbcast:12 row_mask:0xf bank_mask:0xf
    v_and_b32_dpp v34, v40, v6 row_newbcast:12 row_mask:0xf bank_mask:0xf
    v_and_b32_dpp v35, v40, v7 row_newbcast:12 row_mask:0xf bank_mask:0xf
    s_waitcnt vmcnt(6)
    s_cbranch_vccnz L_th21
    s_waitcnt vmcnt(4)
L_th21:
    buffer_load_dwordx4 v[108:111], v10, s[32:35], s48 offen offset:3072 nt
    v_mfma_f32_16x16x32_bf16 v[36:39], v[76:79], v[32:35], v[36:39]
    v_and_b32_dpp v28, v40, v4 row_newbcast:1 row_mask:0xf bank_mask:0xf
    v_and_b32_dpp v29, v40, v5 row_newbcast:1 row_mask:0xf bank_mask:0xf
    v_and_b32_dpp v30, v40, v6 row_newbcast:1 row_mask:0xf bank_mask:0xf
    v_and_b32_dpp v31, v40, v7 row_newbcast:1 row_mask:0xf bank_mask:0xf
    s_waitcnt lgkmcnt(0)
    s_lshl_b32 s89, s88, 4
    s_sub_u32 s87, s89, s86
    s_add_u32 s86, s86, 1704
    s_cmp_gt_i32 s87, 0
    s_cselect_b64 vcc, -1, 0
    s_cmp_eq_u32 s65, 0
    s_cbranch_scc1 L_nr22
    v_mov_b32 v45, s88
    s_mov_b64 exec, 0xffff
    buffer_store_dword v45, v46, s[36:39], s65 offen sc1
    s_mov_b64 exec, -1
    s_add_u32 s65, s65, 512
L_nr22:
    s_waitcnt vmcnt(6)
    s_cbranch_vccnz L_th23
    s_waitcnt vmcnt(4)
L_th23:
    buffer_load_dwordx4 v[112:115], v11, s[32:35], s48 offen nt
    v_mfma_f32_16x16x32_bf16 v[36:39], v[80:83], v[28:31], v[36:39]
    v_and_b32_dpp v32, v40, v4 row_newbcast:9 row_mask:0xf bank_mask:0xf
    v_and_b32_dpp v33, v40, v5 row_newbcast:9 row_mask:0xf bank_mask:0xf
    v_and_b32_dpp v34, v40, v6 row_newbcast:9 row_mask:0xf bank_mask:0xf
    v_and_b32_dpp v35, v40, v7 row_newbcast:9 row_mask:0xf bank_mask:0xf
    ds_read_b32 v42, v27 offset:256
    v_add_u32 v27, 256, v27
    s_waitcnt vmcnt(6)
    s_cbranch_vccnz L_th24
    s_waitcnt vmcnt(4)
L_th24:
    buffer_load_dwordx4 v[116:119], v11, s[32:35], s48 offen offset:1024 nt
    v_mfma_f32_16x16x32_bf16 v[36:39], v[84:87], v[32:35], v[36:39]
    v_and_b32_dpp v28, v40, v4 row_newbcast:5 row_mask:0xf bank_mask:0xf
    v_and_b32_dpp v29, v40, v5 row_newbcast:5 row_mask:0xf bank_mask:0xf
    v_and_b32_dpp v30, v40, v6 row_newbcast:5 row_mask:0xf bank_mask:0xf
    v_and_b32_dpp v31, v40, v7 row_newbcast:5 row_mask:0xf bank_mask:0xf
    s_load_dword s72, s[70:71], 0
    s_load_dword s73, s[70:71], 64
    s_load_dword s74, s[70:71], 128
    s_load_dword s75, s[70:71], 192
    s_load_dword s76, s[70:71], 256
    s_load_dword s77, s[70:71], 320
    s_load_dword s78, s[70:71], 384
    s_load_dword s79, s[70:71], 448
    s_add_u32 s70, s70, 512
    s_addc_u32 s71, s71, 0
    s_waitcnt vmcnt(6)
    s_cbranch_vccnz L_th25
    s_waitcnt vmcnt(4)
L_th25:
    buffer_load_dwordx4 v[120:123], v11, s[32:35], s48 offen offset:2048 nt
    v_mfma_f32_16x16x32_bf16 v[36:39], v[88:91], v[28:31], v[36:39]
    v_and_b32_dpp v32, v40, v4 row_newbcast:13 row_mask:0xf bank_mask:0xf
    v_and_b32_dpp v33, v40, v5 row_newbcast:13 row_mask:0xf bank_mask:0xf
    v_and_b32_dpp v34, v40, v6 row_newbcast:13 row_mask:0xf bank_mask:0xf
    v_and_b32_dpp v35, v40, v7 row_newbcast:13 row_mask:0xf bank_mask:0xf
    s_waitcnt vmcnt(6)
    s_cbranch_vccnz L_th26
    s_waitcnt vmcnt(4)
L_th26:
    buffer_load_dwordx4 v[124:127], v11, s[32:35], s48 offen offset:3072 nt
    v_mfma_f32_16x16x32_bf16 v[36:39], v[92:95], v[32:35], v[36:39]
    v_and_b32_dpp v28, v40, v4 row_newbcast:2 row_mask:0xf bank_mask:0xf
    v_and_b32_dpp v29, v40, v5 row_newbcast:2 row_mask:0xf bank_mask:0xf
    v_and_b32_dpp v30, v40, v6 row_newbcast:2 row_mask:0xf bank_mask:0xf
    v_and_b32_dpp v31, v40, v7 row_newbcast:2 row_mask:0xf bank_mask:0xf
    s_waitcnt vmcnt(6)
    s_cbranch_vccnz L_th27
    s_waitcnt vmcnt(4)
L_th27:
    buffer_load_dwordx4 v[64:67], v8, s[32:35], s49 offen nt
    v_mfma_f32_16x16x32_bf16 v[36:39], v[96:99], v[28:31], v[36:39]
    v_and_b32_dpp v32, v40, v4 row_newbcast:10 row_mask:0xf bank_mask:0xf
    v_and_b32_dpp v33, v40, v5 row_newbcast:10 row_mask:0xf bank_mask:0xf
    v_and_b32_dpp v34, v40, v6 row_newbcast:10 row_mask:0xf bank_mask:0xf
    v_and_b32_dpp v35, v40, v7 row_newbcast:10 row_mask:0xf bank_mask:0xf
    s_waitcnt vmcnt(6)
    s_cbranch_vccnz L_th28
    s_waitcnt vmcnt(4)
L_th28:
    buffer_load_dwordx4 v[68:71], v8, s[32:35], s49 offen offset:1024 nt
    v_mfma_f32_16x16x32_bf16 v[36:39], v[100:103], v[32:35], v[36:39]
    v_and_b32_dpp v28, v40, v4 row_newbcast:6 row_mask:0xf bank_mask:0xf
    v_and_b32_dpp v29, v40, v5 row_newbcast:6 row_mask:0xf bank_mask:0xf
    v_and_b32_dpp v30, v40, v6 row_newbcast:6 row_mask:0xf bank_mask:0xf
    v_and_b32_dpp v31, v40, v7 row_newbcast:6 row_mask:0xf bank_mask:0xf
    s_memrealtime s[88:89]
    s_waitcnt vmcnt(6)
    s_cbranch_vccnz L_th29
    s_waitcnt vmcnt(4)
L_th29:
    buffer_load_dwordx4 v[72:75], v8, s[32:35], s49 offen offset:2048 nt
    v_mfma_f32_16x16x32_bf16 v[36:39], v[104:107], v[28:31], v[36:39]
    v_and_b32_dpp v32, v40, v4 row_newbcast:14 row_mask:0xf bank_mask:0xf
    v_and_b32_dpp v33, v40, v5 row_newbcast:14 row_mask:0xf bank_mask:0xf
    v_and_b32_dpp v34, v40, v6 row_newbcast:14 row_mask:0xf bank_mask:0xf
    v_and_b32_dpp v35, v40, v7 row_newbcast:14 row_mask:0xf bank_mask:0xf
    s_waitcnt vmcnt(6)
    s_cbranch_vccnz L_th30
    s_waitcnt vmcnt(4)
L_th30:
    buffer_load_dwordx4 v[76:79], v8, s[32:35], s49 offen offset:3072 nt
    v_mfma_f32_16x16x32_bf16 v[36:39], v[108:111], v[32:35], v[36:39]
    v_and_b32_dpp v28, v40, v4 row_newbcast:3 row_mask:0xf bank_mask:0xf
    v_and_b32_dpp v29, v40, v5 row_newbcast:3 row_mask:0xf bank_mask:0xf
    v_and_b32_dpp v30, v40, v6 row_newbcast:3 row_mask:0xf bank_mask:0xf
    v_and_b32_dpp v31, v40, v7 row_newbcast:3 row_mask:0xf bank_mask:0xf
    s_waitcnt lgkmcnt(0)
    s_lshl_b32 s89, s88, 4
    s_sub_u32 s87, s89, s86
    s_add_u32 s86, s86, 1704
    s_cmp_gt_i32 s87, 0
    s_cselect_b64 vcc, -1, 0
    s_sub_u32 s72, s88, s72
    s_sub_u32 s73, s88, s73
    s_sub_u32 s74, s88, s74
    s_sub_u32 s75, s88, s75
    s_sub_u32 s76, s88, s76
    s_sub_u32 s77, s88, s77
    s_sub_u32 s78, s88, s78
    s_sub_u32 s79, s88, s79
    s_max_u32 s80, s72, s73
    s_add_u32 s81, s72, s73
    s_max_u32 s80, s80, s74
    s_add_u32 s81, s81, s74
    s_max_u32 s80, s80, s75
    s_add_u32 s81, s81, s75
    s_max_u32 s80, s80, s76
    s_add_u32 s81, s81, s76
    s_max_u32 s80, s80, s77
    s_add_u32 s81, s81, s77
    s_max_u32 s80, s80, s78
    s_add_u32 s81, s81, s78
    s_max_u32 s80, s80, s79
    s_add_u32 s81, s81, s79
    s_lshl_b32 s81, s81, 1
    s_sub_u32 s81, s89, s81
    s_add_u32 s81, s81, 10384
    s_cmp_lt_u32 s80, 1500
    s_cselect_b32 s86, s81, s86
    s_waitcnt vmcnt(6)
    s_cbranch_vccnz L_th31
    s_waitcnt vmcnt(4)
L_th31:
    buffer_load_dwordx4 v[80:83], v9, s[32:35], s49 offen nt
    v_mfma_f32_16x16x32_bf16 v[36:39], v[112:115], v[28:31], v[36:39]
    v_and_b32_dpp v32, v40, v4 row_newbcast:11 row_mask:0xf bank_mask:0xf
    v_and_b32_dpp v33, v40, v5 row_newbcast:11 row_mask:0xf bank_mask:0xf
    v_and_b32_dpp v34, v40, v6 row_newbcast:11 row_mask:0xf bank_mask:0xf
    v_and_b32_dpp v35, v40, v7 row_newbcast:11 row_mask:0xf bank_mask:0xf
    v_fma_f32 v42, v42, s61, -v43
    v_exp_f32 v42, v42
    s_nop 0
    v_cvt_pk_bf16_f32 v41, v42, v42
    s_waitcnt vmcnt(6)
    s_cbranch_vccnz L_th32
    s_waitcnt vmcnt(4)
L_th32:
    buffer_load_dwordx4 v[84:87], v9, s[32:35], s49 offen offset:1024 nt
    v_mfma_f32_16x16x32_bf16 v[36:39], v[116:119], v[32:35], v[36:39]
    v_and_b32_dpp v28, v40, v4 row_newbcast:7 row_mask:0xf bank_mask:0xf
    v_and_b32_dpp v29, v40, v5 row_newbcast:7 row_mask:0xf bank_mask:0xf
    v_and_b32_dpp v30, v40, v6 row_newbcast:7 row_mask:0xf bank_mask:0xf
    v_and_b32_dpp v31, v40, v7 row_newbcast:7 row_mask:0xf bank_mask:0xf
    s_waitcnt vmcnt(6)
    s_cbranch_vccnz L_th33
    s_waitcnt vmcnt(4)
L_th33:
    buffer_load_dwordx4 v[88:91], v9, s[32:35], s49 offen offset:2048 nt
    v_mfma_f32_16x16x32_bf16 v[36:39], v[120:123], v[28:31], v[36:39]
    v_and_b32_dpp v32, v40, v4 row_newbcast:15 row_mask:0xf bank_mask:0xf
    v_and_b32_dpp v33, v40, v5 row_newbcast:15 row_mask:0xf bank_mask:0xf
    v_and_b32_dpp v34, v40, v6 row_newbcast:15 row_mask:0xf bank_mask:0xf
    v_and_b32_dpp v35, v40, v7 row_newbcast:15 row_mask:0xf bank_mask:0xf
    s_waitcnt vmcnt(6)
    s_cbranch_vccnz L_th34
    s_waitcnt vmcnt(4)
L_th34:
    buffer_load_dwordx4 v[92:95], v9, s[32:35], s49 offen offset:3072 nt
    v_mfma_f32_16x16x32_bf16 v[36:39], v[124:127], v[32:35], v[36:39]
    s_cmp_eq_u32 s50, 1
    s_cbranch_scc1 L_vdone
    v_and_b32_dpp v28, v41, v4 row_newbcast:0 row_mask:0xf bank_mask:0xf
    v_and_b32_dpp v29, v41, v5 row_newbcast:0 row_mask:0xf bank_mask:0xf
    v_and_b32_dpp v30, v41, v6 row_newbcast:0 row_mask:0xf bank_mask:0xf
    v_and_b32_dpp v31, v41, v7 row_newbcast:0 row_mask:0xf bank_mask:0xf
    v_mov_b32 v40, v41
    s_mov_b32 s48, s49
    s_add_u32 s67, s67, 0x20000
    s_sub_u32 s50, s50, 1
    s_branch L_vloop
L_vdone:
    s_nop 5
    ds_write2_b32 v25, v36, v37 offset0:0 offset1:8
    ds_write2_b32 v25, v38, v39 offset0:16 offset1:24
    s_waitcnt lgkmcnt(0)
    s_barrier
    s_endpgm
L_aux:
    s_setprio 3
    s_sub_u32 s40, s40, 4
    v_lshlrev_b32 v38, 2, v0
    v_lshrrev_b32 v1, 4, v0
    v_and_b32 v2, 15, v0
    s_mul_i32 s43, s42, 80
    s_mul_i32 s44, s40, 20
    s_add_u32 s44, s44, s43
    v_mad_u32_u24 v37, v1, 5, s44
    v_lshlrev_b32 v36, 13, v37
    v_lshl_add_u32 v36, v2, 4, v36
    s_and_b32 s44, s40, 1
    s_mul_i32 s44, s44, 40
    s_add_u32 s44, s44, s43
    v_lshrrev_b32 v3, 3, v0
    v_mad_u32_u24 v39, v3, 5, s44
    v_mul_u32_u24 v3, 3456, v39
    v_and_b32 v8, 7, v0
    v_lshl_add_u32 v3, v8, 4, v3
    s_mov_b32 s34, 1280
    s_mov_b32 s30, 5242880
    s_mov_b32 s38, 1294592
    s_mov_b32 s51, 0x20000
    s_lshl_b32 s43, s41, 8
    s_lshl_b32 s44, s41, 7
    s_cmp_lt_u32 s41, 27
    s_cselect_b32 s50, 2211840, 0
    s_waitcnt lgkmcnt(0)
    s_mov_b32 s32, s4
    s_mov_b32 s33, s5
    s_mov_b32 s28, s10
    s_mov_b32 s29, s11
    s_mov_b32 s36, s26
    s_mov_b32 s37, s27
    buffer_load_dword v60, v38, s[32:35], 0 offen offset:0
    buffer_load_dword v61, v38, s[32:35], 0 offen offset:256
    buffer_load_dword v62, v38, s[32:35], 0 offen offset:512
    buffer_load_dword v63, v38, s[32:35], 0 offen offset:768
    buffer_load_dword v64, v38, s[32:35], 0 offen offset:1024
    buffer_load_dwordx4 v[96:99], v36, s[28:31], s43 offen nt
    s_add_u32 s43, s43, 8192
    buffer_load_dwordx4 v[100:103], v36, s[28:31], s43 offen nt
    s_add_u32 s43, s43, 8192
    buffer_load_dwordx4 v[104:107], v36, s[28:31], s43 offen nt
    s_add_u32 s43, s43, 8192
    buffer_load_dwordx4 v[108:111], v36, s[28:31], s43 offen nt
    s_add_u32 s43, s43, 8192
    buffer_load_dwordx4 v[112:115], v36, s[28:31], s43 offen nt
    s_barrier
    s_cmp_lt_u32 s40, 2
    s_cselect_b32 s48, s16, s18
    s_cselect_b32 s49, s17, s19
    buffer_load_dwordx4 v[116:119], v3, s[48:51], s44 offen nt
    s_add_u32 s44, s44, 3456
    buffer_load_dwordx4 v[120:123], v3, s[48:51], s44 offen nt
    s_add_u32 s44, s44, 3456
    buffer_load_dwordx4 v[124:127], v3, s[48:51], s44 offen nt
    s_add_u32 s44, s44, 3456
    buffer_load_dwordx4 v[128:131], v3, s[48:51], s44 offen nt
    s_add_u32 s44, s44, 3456
    buffer_load_dwordx4 v[132:135], v3, s[48:51], s44 offen nt
    s_mov_b32 s62, 0
    s_add_u32 s70, s26, 1277952
    s_addc_u32 s71, s27, 0
    s_load_dwordx2 s[72:73], s[70:71], 0
    v_lshlrev_b32 v37, 2, v37
    v_lshlrev_b32 v36, 2, v39
    v_and_b32 v1, 1, v0
    v_lshlrev_b32 v1, 4, v1
    v_mov_b32 v2, 0xffff
    v_lshlrev_b32 v2, v1, v2
    v_bfe_u32 v1, v0, 1, 2
    v_cmp_eq_u32 vcc, 0, v1
    s_nop 1
    v_cndmask_b32 v4, 0, v2, vcc
    v_cmp_eq_u32 vcc, 1, v1
    s_nop 1
    v_cndmask_b32 v5, 0, v2, vcc
    v_cmp_eq_u32 vcc, 2, v1
    s_nop 1
    v_cndmask_b32 v6, 0, v2, vcc
    v_cmp_eq_u32 vcc, 3, v1
    s_nop 1
    v_cndmask_b32 v7, 0, v2, vcc
    v_lshrrev_b32 v1, 4, v0
    v_and_b32 v2, 15, v0
    s_lshl_b32 s45, s40, 6
    v_add_u32 v3, s45, v0
    v_lshlrev_b32 v94, 4, v3
    v_and_b32 v95, 48, v94
    v_lshrrev_b32 v92, 2, v3
    v_lshl_add_u32 v92, v92, 14, v95
    v_cmp_gt_u32 vcc, 160, v3
    v_lshlrev_b32 v93, 7, v1
    v_and_b32 v39, 7, v0
    v_lshl_add_u32 v80, v39, 2, v93
    v_lshl_add_u32 v93, v39, 4, v93
    s_mul_i32 s45, s40, 2560
    s_add_u32 s45, s45, 30592
    v_add_u32 v93, s45, v93
    s_lshl_b32 s45, s40, 9
    v_add_u32 v80, s45, v80
    s_mov_b64 s[68:69], vcc
    s_lshl_b32 s63, s41, 3
    s_add_u32 s63, s63, s42
    s_lshl_b32 s63, s63, 6
    v_mov_b32 v91, 0
    v_lshlrev_b32 v88, 4, v0
    s_waitcnt vmcnt(10)
    v_lshlrev_b32 v66, 16, v60
    v_and_b32 v67, 0xffff0000, v60
    v_lshlrev_b32 v68, 16, v61
    v_and_b32 v69, 0xffff0000, v61
    v_lshlrev_b32 v70, 16, v62
    v_and_b32 v71, 0xffff0000, v62
    v_lshlrev_b32 v72, 16, v63
    v_and_b32 v73, 0xffff0000, v63
    v_lshlrev_b32 v74, 16, v64
    v_and_b32 v75, 0xffff0000, v64
    v_add_f32 v8, v66, v67
    v_add_f32 v8, v8, v68
    v_add_f32 v8, v8, v69
    v_add_f32 v8, v8, v70
    v_add_f32 v8, v8, v71
    v_add_f32 v8, v8, v72
    v_add_f32 v8, v8, v73
    v_add_f32 v8, v8, v74
    v_add_f32 v8, v8, v75
    s_nop 1
    v_add_f32_dpp v8, v8, v8 quad_perm:[1,0,3,2] row_mask:0xf bank_mask:0xf
    s_nop 1
    v_add_f32_dpp v8, v8, v8 quad_perm:[2,3,0,1] row_mask:0xf bank_mask:0xf
    s_nop 1
    v_add_f32_dpp v8, v8, v8 row_half_mirror row_mask:0xf bank_mask:0xf
    s_nop 1
    v_add_f32_dpp v8, v8, v8 row_ror:8 row_mask:0xf bank_mask:0xf
    v_mov_b32 v9, v8
    s_nop 1
    v_permlane16_swap_b32 v9, v8
    v_add_f32 v8, v8, v9
    v_mov_b32 v9, v8
    s_nop 1
    v_permlane32_swap_b32 v9, v8
    v_add_f32 v8, v8, v9
    v_mul_f32 v8, 0x3acccccd, v8
    v_sub_f32 v10, v66, v8
    v_mul_f32 v11, v10, v10
    v_sub_f32 v10, v67, v8
    v_fmac_f32 v11, v10, v10
    v_sub_f32 v10, v68, v8
    v_fmac_f32 v11, v10, v10
    v_sub_f32 v10, v69, v8
    v_fmac_f32 v11, v10, v10
    v_sub_f32 v10, v70, v8
    v_fmac_f32 v11, v10, v10
    v_sub_f32 v10, v71, v8
    v_fmac_f32 v11, v10, v10
    v_sub_f32 v10, v72, v8
    v_fmac_f32 v11, v10, v10
    v_sub_f32 v10, v73, v8
    v_fmac_f32 v11, v10, v10
    v_sub_f32 v10, v74, v8
    v_fmac_f32 v11, v10, v10
    v_sub_f32 v10, v75, v8
    v_fmac_f32 v11, v10, v10
    s_nop 1
    v_add_f32_dpp v11, v11, v11 quad_perm:[1,0,3,2] row_mask:0xf bank_mask:0xf
    s_nop 1
    v_add_f32_dpp v11, v11, v11 quad_perm:[2,3,0,1] row_mask:0xf bank_mask:0xf
    s_nop 1
    v_add_f32_dpp v11, v11, v11 row_half_mirror row_mask:0xf bank_mask:0xf
    s_nop 1
    v_add_f32_dpp v11, v11, v11 row_ror:8 row_mask:0xf bank_mask:0xf
    v_mov_b32 v9, v11
    s_nop 1
    v_permlane16_swap_b32 v9, v11
    v_add_f32 v11, v11, v9
    v_mov_b32 v9, v11
    s_nop 1
    v_permlane32_swap_b32 v9, v11
    v_add_f32 v11, v11, v9
    v_mul_f32 v11, 0x3acccccd, v11
    v_cvt_pk_bf16_f32 v8, v8, v8
    v_and_b32 v8, 0xffff0000, v8
    v_cvt_pk_bf16_f32 v11, v11, v11
    v_and_b32 v11, 0xffff0000, v11
    v_add_f32 v11, 0x3727c5ac, v11
    v_cvt_pk_bf16_f32 v11, v11, v11
    v_and_b32 v11, 0xffff0000, v11
    v_sqrt_f32 v11, v11
    s_nop 0
    v_cvt_pk_bf16_f32 v11, v11, v11
    v_and_b32 v11, 0xffff0000, v11
    v_rcp_f32 v12, v11
    v_sub_f32 v66, v66, v8
    v_cvt_pk_bf16_f32 v66, v66, v66
    v_and_b32 v66, 0xffff0000, v66
    v_sub_f32 v67, v67, v8
    v_cvt_pk_bf16_f32 v67, v67, v67
    v_and_b32 v67, 0xffff0000, v67
    v_sub_f32 v68, v68, v8
    v_cvt_pk_bf16_f32 v68, v68, v68
    v_and_b32 v68, 0xffff0000, v68
    v_sub_f32 v69, v69, v8
    v_cvt_pk_bf16_f32 v69, v69, v69
    v_and_b32 v69, 0xffff0000, v69
    v_sub_f32 v70, v70, v8
    v_cvt_pk_bf16_f32 v70, v70, v70
    v_and_b32 v70, 0xffff0000, v70
    v_sub_f32 v71, v71, v8
    v_cvt_pk_bf16_f32 v71, v71, v71
    v_and_b32 v71, 0xffff0000, v71
    v_sub_f32 v72, v72, v8
    v_cvt_pk_bf16_f32 v72, v72, v72
    v_and_b32 v72, 0xffff0000, v72
    v_sub_f32 v73, v73, v8
    v_cvt_pk_bf16_f32 v73, v73, v73
    v_and_b32 v73, 0xffff0000, v73
    v_sub_f32 v74, v74, v8
    v_cvt_pk_bf16_f32 v74, v74, v74
    v_and_b32 v74, 0xffff0000, v74
    v_sub_f32 v75, v75, v8
    v_cvt_pk_bf16_f32 v75, v75, v75
    v_and_b32 v75, 0xffff0000, v75
    v_mul_f32 v10, v66, v12
    v_fma_f32 v66, -v10, v11, v66
    v_fma_f32 v10, v66, v12, v10
    v_cvt_pk_bf16_f32 v66, v10, v10
    v_mul_f32 v10, v67, v12
    v_fma_f32 v67, -v10, v11, v67
    v_fma_f32 v10, v67, v12, v10
    v_cvt_pk_bf16_f32 v67, v10, v10
    v_mul_f32 v10, v68, v12
    v_fma_f32 v68, -v10, v11, v68
    v_fma_f32 v10, v68, v12, v10
    v_cvt_pk_bf16_f32 v68, v10, v10
    v_mul_f32 v10, v69, v12
    v_fma_f32 v69, -v10, v11, v69
    v_fma_f32 v10, v69, v12, v10
    v_cvt_pk_bf16_f32 v69, v10, v10
    v_mul_f32 v10, v70, v12
    v_fma_f32 v70, -v10, v11, v70
    v_fma_f32 v10, v70, v12, v10
    v_cvt_pk_bf16_f32 v70, v10, v10
    v_mul_f32 v10, v71, v12
    v_fma_f32 v71, -v10, v11, v71
    v_fma_f32 v10, v71, v12, v10
    v_cvt_pk_bf16_f32 v71, v10, v10
    v_mul_f32 v10, v72, v12
    v_fma_f32 v72, -v10, v11, v72
    v_fma_f32 v10, v72, v12, v10
    v_cvt_pk_bf16_f32 v72, v10, v10
    v_mul_f32 v10, v73, v12
    v_fma_f32 v73, -v10, v11, v73
    v_fma_f32 v10, v73, v12, v10
    v_cvt_pk_bf16_f32 v73, v10, v10
    v_mul_f32 v10, v74, v12
    v_fma_f32 v74, -v10, v11, v74
    v_fma_f32 v10, v74, v12, v10
    v_cvt_pk_bf16_f32 v74, v10, v10
    v_mul_f32 v10, v75, v12
    v_fma_f32 v75, -v10, v11, v75
    v_fma_f32 v10, v75, v12, v10
    v_cvt_pk_bf16_f32 v75, v10, v10
    v_lshlrev_b32 v38, 3, v0
    ds_write_b64 v38, v[66:67] offset:0
    ds_write_b64 v38, v[68:69] offset:512
    ds_write_b64 v38, v[70:71] offset:1024
    ds_write_b64 v38, v[72:73] offset:1536
    ds_write_b64 v38, v[74:75] offset:2048
    ds_read2_b32 v[40:41], v37 offset0:0 offset1:1
    ds_read2_b32 v[42:43], v37 offset0:2 offset1:3
    ds_read_b32 v44, v37 offset:16
    ds_read2_b32 v[46:47], v36 offset0:0 offset1:1
    ds_read2_b32 v[48:49], v36 offset0:2 offset1:3
    ds_read_b32 v50, v36 offset:16
    s_waitcnt lgkmcnt(0)
    s_mul_i32 s74, s72, 0x9E3779B5
    s_mul_hi_u32 s75, s72, 0x9E3779B5
    s_mul_i32 s73, s73, 0x9E3779B5
    s_add_u32 s75, s75, s73
    s_add_u32 s74, s74, 0x7F4A7C15
    s_addc_u32 s75, s75, 0x1B873593
    v_and_b32 v8, v40, v4
    v_and_b32 v9, v40, v5
    v_and_b32 v10, v40, v6
    v_and_b32 v11, v40, v7
    v_and_b32 v12, v41, v4
    v_and_b32 v13, v41, v5
    v_and_b32 v14, v41, v6
    v_and_b32 v15, v41, v7
    s_waitcnt vmcnt(5)
    v_mfma_f32_16x16x32_bf16 v[16:19], v[96:99], v[8:11], 0
    v_and_b32 v8, v42, v4
    v_and_b32 v9, v42, v5
    v_and_b32 v10, v42, v6
    v_and_b32 v11, v42, v7
    v_mfma_f32_16x16x32_bf16 v[16:19], v[100:103], v[12:15], v[16:19]
    v_and_b32 v12, v43, v4
    v_and_b32 v13, v43, v5
    v_and_b32 v14, v43, v6
    v_and_b32 v15, v43, v7
    v_mfma_f32_16x16x32_bf16 v[16:19], v[104:107], v[8:11], v[16:19]
    v_and_b32 v8, v44, v4
    v_and_b32 v9, v44, v5
    v_and_b32 v10, v44, v6
    v_and_b32 v11, v44, v7
    v_mfma_f32_16x16x32_bf16 v[16:19], v[108:111], v[12:15], v[16:19]
    s_nop 1
    v_mfma_f32_16x16x32_bf16 v[16:19], v[112:115], v[8:11], v[16:19]
    v_add_u32 v38, 2560, v80
    v_lshlrev_b32 v37, 3, v0
    v_and_b32 v36, 32, v0
    v_mul_u32_u24 v36, 24, v36
    v_add_u32 v36, v36, v37
    s_nop 2
    ds_write2_b32 v38, v16, v17 offset0:0 offset1:8
    ds_write2_b32 v38, v18, v19 offset0:16 offset1:24
    s_add_u32 s62, s62, 4
    v_mov_b32 v39, 12800
    v_mov_b32 v3, 1
    s_waitcnt lgkmcnt(0)
    s_mov_b64 exec, 1
    ds_add_u32 v39, v3
    s_mov_b64 exec, -1
L_sync_q:
    ds_read_b32 v3, v39
    s_waitcnt lgkmcnt(0)
    v_readfirstlane_b32 s43, v3
    s_cmp_lt_u32 s43, s62
    s_cbranch_scc1 L_sync_q
    s_cmp_lg_u32 s40, 0
    s_cbranch_scc1 L_nopubq
    ds_read_b64 v[52:53], v37 offset:2560
    ds_read_b64 v[54:55], v37 offset:3072
    ds_read_b64 v[56:57], v37 offset:3584
    ds_read_b64 v[58:59], v37 offset:4096
    v_mov_b32 v30, s74
    v_mov_b32 v31, s75
    s_lshl_b32 s45, s63, 4
    s_add_u32 s45, s45, 753664
    s_waitcnt lgkmcnt(0)
    v_add_f32 v52, v52, v54
    v_add_f32 v56, v56, v58
    v_add_f32 v28, v52, v56
    v_add_f32 v53, v53, v55
    v_add_f32 v57, v57, v59
    v_add_f32 v29, v53, v57
    buffer_store_dwordx4 v[28:31], v88, s[36:39], s45 offen sc1
L_nopubq:
    s_cmp_eq_u32 s40, 0
    s_cbranch_scc1 L_w1
    s_waitcnt vmcnt(0)
L_w1:
    v_and_b32 v8, v46, v4
    v_and_b32 v9, v46, v5
    v_and_b32 v10, v46, v6
    v_and_b32 v11, v46, v7
    v_and_b32 v12, v47, v4
    v_and_b32 v13, v47, v5
    v_and_b32 v14, v47, v6
    v_and_b32 v15, v47, v7
    s_waitcnt vmcnt(1)
    v_mfma_f32_16x16x32_bf16 v[20:23], v[116:119], v[8:11], 0
    v_and_b32 v8, v48, v4
    v_and_b32 v9, v48, v5
    v_and_b32 v10, v48, v6
    v_and_b32 v11, v48, v7
    v_mfma_f32_16x16x32_bf16 v[20:23], v[120:123], v[12:15], v[20:23]
    v_and_b32 v12, v49, v4
    v_and_b32 v13, v49, v5
    v_and_b32 v14, v49, v6
    v_and_b32 v15, v49, v7
    v_mfma_f32_16x16x32_bf16 v[20:23], v[124:127], v[8:11], v[20:23]
    v_and_b32 v8, v50, v4
    v_and_b32 v9, v50, v5
    v_and_b32 v10, v50, v6
    v_and_b32 v11, v50, v7
    v_mfma_f32_16x16x32_bf16 v[20:23], v[128:131], v[12:15], v[20:23]
    s_nop 1
    v_mfma_f32_16x16x32_bf16 v[20:23], v[132:135], v[8:11], v[20:23]
    v_add_u32 v38, 4608, v80
    s_mov_b32 exec_lo, 0x00ff00ff
    s_mov_b32 exec_hi, 0xff00ff00
    s_nop 4
    ds_write2_b32 v38, v20, v21 offset0:0 offset1:8
    ds_write2_b32 v38, v22, v23 offset0:16 offset1:24
    s_mov_b64 exec, -1
    s_add_u32 s62, s62, 4
    v_mov_b32 v39, 12800
    v_mov_b32 v3, 1
    s_waitcnt lgkmcnt(0)
    s_mov_b64 exec, 1
    ds_add_u32 v39, v3
    s_mov_b64 exec, -1
L_sync_gu:
    ds_read_b32 v3, v39
    s_waitcnt lgkmcnt(0)
    v_readfirstlane_b32 s43, v3
    s_cmp_lt_u32 s43, s62
    s_cbranch_scc1 L_sync_gu
    s_cmp_lg_u32 s40, 1
    s_cbranch_scc1 L_nopubg
    ds_read_b64 v[52:53], v36 offset:4608
    ds_read_b64 v[54:55], v36 offset:4864
    ds_read_b64 v[56:57], v36 offset:5120
    ds_read_b64 v[58:59], v36 offset:5376
    v_mov_b32 v30, s74
    v_mov_b32 v31, s75
    s_lshl_b32 s45, s63, 4
    s_add_u32 s45, s45, 1015808
    s_waitcnt lgkmcnt(0)
    v_add_f32 v52, v52, v54
    v_add_f32 v56, v56, v58
    v_add_f32 v28, v52, v56
    v_add_f32 v53, v53, v55
    v_add_f32 v57, v57, v59
    v_add_f32 v29, v53, v57
    buffer_store_dwordx4 v[28:31], v88, s[36:39], s45 offen sc1
L_nopubg:
    v_mov_b32 v24, -1
    v_mov_b32 v25, -1
    v_mov_b32 v26, -1
    v_mov_b32 v27, -1
    s_cmp_ge_u32 s40, 3
    s_cbranch_scc1 L_nos
    s_mov_b64 exec, s[68:69]
    buffer_store_dwordx4 v[24:27], v92, s[36:39], s63 offen sc1
    s_mov_b64 exec, -1
L_nos:
    s_barrier
    s_lshl_b32 s45, s41, 13
    s_lshl_b32 s44, s40, 11
    s_add_u32 s45, s45, s44
    s_add_u32 s45, s45, 753664
    s_mov_b32 s47, 1000000
L_gq:
    s_sleep 1
    buffer_load_dwordx4 v[40:43], v88, s[36:39], s45 offen sc1
    buffer_load_dwordx4 v[44:47], v88, s[36:39], s45 offen offset:1024 sc1
    s_sub_u32 s47, s47, 1
    s_cbranch_scc1 L_gxq
    s_waitcnt vmcnt(0)
    v_cmp_ne_u64 vcc, s[74:75], v[42:43]
    v_cmp_ne_u64_e64 s[52:53], s[74:75], v[46:47]
    s_or_b64 vcc, vcc, s[52:53]
    s_cbranch_scc1 L_gq
L_gxq:
    s_waitcnt vmcnt(0)
    v_add_f32 v40, v40, v44
    v_add_f32 v41, v41, v45
    s_lshl_b32 s44, s40, 9
    v_lshl_add_u32 v3, v0, 3, s44
    ds_write_b64 v3, v[40:41] offset:6656
    s_waitcnt lgkmcnt(0)
    s_barrier
    s_setprio 0
    s_cmp_lg_u32 s42, 0
    s_cbranch_scc1 L_noffn
    s_cmp_ge_u32 s41, 27
    s_cbranch_scc1 L_noffn
    s_lshl_b32 s45, s41, 13
    s_lshl_b32 s44, s40, 11
    s_add_u32 s45, s45, s44
    s_add_u32 s45, s45, 1015808
    s_mov_b32 s47, 1000000
L_gg:
    s_sleep 8
    buffer_load_dwordx4 v[40:43], v88, s[36:39], s45 offen sc1
    buffer_load_dwordx4 v[44:47], v88, s[36:39], s45 offen offset:1024 sc1
    s_sub_u32 s47, s47, 1
    s_cbranch_scc1 L_gxg
    s_waitcnt vmcnt(0)
    v_cmp_ne_u64 vcc, s[74:75], v[42:43]
    v_cmp_ne_u64_e64 s[52:53], s[74:75], v[46:47]
    s_or_b64 vcc, vcc, s[52:53]
    s_cbranch_scc1 L_gg
L_gxg:
    s_waitcnt vmcnt(0)
    v_add_f32 v40, v40, v44
    v_add_f32 v41, v41, v45
    s_lshl_b32 s44, s40, 9
    v_lshl_add_u32 v3, v0, 3, s44
    ds_write_b64 v3, v[40:41] offset:8704
    s_mov_b32 s28, s20
    s_mov_b32 s29, s21
    s_mov_b32 s30, 2211840
    s_lshl_b32 s43, s41, 6
    s_lshl_b32 s45, s40, 4
    s_add_u32 s43, s43, s45
    v_lshl_add_u32 v3, v1, 2, s43
    v_mul_u32_u24 v36, 1280, v3
    v_lshl_add_u32 v36, v2, 4, v36
    s_mov_b32 s43, 0
    buffer_load_dwordx4 v[96:99], v36, s[28:31], s43 offen offset:0
    buffer_load_dwordx4 v[100:103], v36, s[28:31], s43 offen offset:256
    s_waitcnt vmcnt(1)
    buffer_load_dwordx4 v[104:107], v36, s[28:31], s43 offen offset:512
    s_waitcnt vmcnt(1)
    buffer_load_dwordx4 v[108:111], v36, s[28:31], s43 offen offset:768
    s_waitcnt vmcnt(1)
    buffer_load_dwordx4 v[112:115], v36, s[28:31], s43 offen offset:1024
    s_mov_b32 s43, 1280
    s_waitcnt vmcnt(1)
    buffer_load_dwordx4 v[116:119], v36, s[28:31], s43 offen offset:0
    s_waitcnt vmcnt(1)
    buffer_load_dwordx4 v[120:123], v36, s[28:31], s43 offen offset:256
    s_waitcnt vmcnt(1)
    buffer_load_dwordx4 v[124:127], v36, s[28:31], s43 offen offset:512
    s_waitcnt vmcnt(1)
    buffer_load_dwordx4 v[128:131], v36, s[28:31], s43 offen offset:768
    s_waitcnt vmcnt(1)
    buffer_load_dwordx4 v[132:135], v36, s[28:31], s43 offen offset:1024
    s_mov_b32 s43, 2560
    s_waitcnt vmcnt(1)
    buffer_load_dwordx4 v[136:139], v36, s[28:31], s43 offen offset:0
    s_waitcnt vmcnt(1)
    buffer_load_dwordx4 v[140:143], v36, s[28:31], s43 offen offset:256
    s_waitcnt vmcnt(1)
    buffer_load_dwordx4 v[144:147], v36, s[28:31], s43 offen offset:512
    s_waitcnt vmcnt(1)
    buffer_load_dwordx4 v[148:151], v36, s[28:31], s43 offen offset:768
    s_waitcnt vmcnt(1)
    buffer_load_dwordx4 v[152:155], v36, s[28:31], s43 offen offset:1024
    s_mov_b32 s43, 3840
    s_waitcnt vmcnt(1)
    buffer_load_dwordx4 v[156:159], v36, s[28:31], s43 offen offset:0
    s_waitcnt vmcnt(1)
    buffer_load_dwordx4 v[160:163], v36, s[28:31], s43 offen offset:256
    s_waitcnt vmcnt(1)
    buffer_load_dwordx4 v[164:167], v36, s[28:31], s43 offen offset:512
    s_waitcnt vmcnt(1)
    buffer_load_dwordx4 v[168:171], v36, s[28:31], s43 offen offset:768
    s_waitcnt vmcnt(1)
    buffer_load_dwordx4 v[172:175], v36, s[28:31], s43 offen offset:1024
    s_add_u32 s62, s62, 4
    v_mov_b32 v39, 12800
    v_mov_b32 v3, 1
    s_waitcnt lgkmcnt(0)
    s_mov_b64 exec, 1
    ds_add_u32 v39, v3
    s_mov_b64 exec, -1
L_sync_gs:
    ds_read_b32 v3, v39
    s_waitcnt lgkmcnt(0)
    v_readfirstlane_b32 s43, v3
    s_cmp_lt_u32 s43, s62
    s_cbranch_scc1 L_sync_gs
    s_lshl_b32 s43, s40, 6
    v_lshl_add_u32 v38, v1, 4, s43
    ds_read_b128 v[48:51], v38 offset:8704
    ds_read_b128 v[64:67], v38 offset:8960
    ds_read_b128 v[52:55], v38 offset:9216
    ds_read_b128 v[68:71], v38 offset:9472
    ds_read_b128 v[56:59], v38 offset:9728
    ds_read_b128 v[72:75], v38 offset:9984
    ds_read_b128 v[60:63], v38 offset:10240
    ds_read_b128 v[76:79], v38 offset:10496
    s_waitcnt lgkmcnt(0)
    v_add_f32 v48, v48, v52
    v_add_f32 v56, v56, v60
    v_add_f32 v48, v48, v56
    v_add_f32 v64, v64, v68
    v_add_f32 v72, v72, v76
    v_add_f32 v64, v64, v72
    v_cvt_pk_bf16_f32 v48, v48, v48
    v_and_b32 v48, 0xffff0000, v48
    v_cvt_pk_bf16_f32 v64, v64, v64
    v_and_b32 v64, 0xffff0000, v64
    v_max_f32 v48, 0, v48
    v_mul_f32 v48, v48, v64
    v_cvt_pk_bf16_f32 v40, v48, v48
    v_add_f32 v49, v49, v53
    v_add_f32 v57, v57, v61
    v_add_f32 v49, v49, v57
    v_add_f32 v65, v65, v69
    v_add_f32 v73, v73, v77
    v_add_f32 v65, v65, v73
    v_cvt_pk_bf16_f32 v49, v49, v49
    v_and_b32 v49, 0xffff0000, v49
    v_cvt_pk_bf16_f32 v65, v65, v65
    v_and_b32 v65, 0xffff0000, v65
    v_max_f32 v49, 0, v49
    v_mul_f32 v49, v49, v65
    v_cvt_pk_bf16_f32 v41, v49, v49
    v_add_f32 v50, v50, v54
    v_add_f32 v58, v58, v62
    v_add_f32 v50, v50, v58
    v_add_f32 v66, v66, v70
    v_add_f32 v74, v74, v78
    v_add_f32 v66, v66, v74
    v_cvt_pk_bf16_f32 v50, v50, v50
    v_and_b32 v50, 0xffff0000, v50
    v_cvt_pk_bf16_f32 v66, v66, v66
    v_and_b32 v66, 0xffff0000, v66
    v_max_f32 v50, 0, v50
    v_mul_f32 v50, v50, v66
    v_cvt_pk_bf16_f32 v42, v50, v50
    v_add_f32 v51, v51, v55
    v_add_f32 v59, v59, v63
    v_add_f32 v51, v51, v59
    v_add_f32 v67, v67, v71
    v_add_f32 v75, v75, v79
    v_add_f32 v67, v67, v75
    v_cvt_pk_bf16_f32 v51, v51, v51
    v_and_b32 v51, 0xffff0000, v51
    v_cvt_pk_bf16_f32 v67, v67, v67
    v_and_b32 v67, 0xffff0000, v67
    v_max_f32 v51, 0, v51
    v_mul_f32 v51, v51, v67
    v_cvt_pk_bf16_f32 v43, v51, v51
    s_waitcnt vmcnt(0)
    v_and_b32 v8, v40, v4
    v_and_b32 v9, v40, v5
    v_and_b32 v10, v40, v6
    v_and_b32 v11, v40, v7
    v_and_b32 v12, v41, v4
    v_and_b32 v13, v41, v5
    v_and_b32 v14, v41, v6
    v_and_b32 v15, v41, v7
    v_mfma_f32_16x16x32_bf16 v[16:19], v[96:99], v[8:11], 0
    v_mfma_f32_16x16x32_bf16 v[20:23], v[100:103], v[8:11], 0
    v_mfma_f32_16x16x32_bf16 v[24:27], v[104:107], v[8:11], 0
    v_mfma_f32_16x16x32_bf16 v[28:31], v[108:111], v[8:11], 0
    v_mfma_f32_16x16x32_bf16 v[32:35], v[112:115], v[8:11], 0
    v_and_b32 v8, v42, v4
    v_and_b32 v9, v42, v5
    v_and_b32 v10, v42, v6
    v_and_b32 v11, v42, v7
    v_mfma_f32_16x16x32_bf16 v[16:19], v[116:119], v[12:15], v[16:19]
    v_mfma_f32_16x16x32_bf16 v[20:23], v[120:123], v[12:15], v[20:23]
    v_mfma_f32_16x16x32_bf16 v[24:27], v[124:127], v[12:15], v[24:27]
    v_mfma_f32_16x16x32_bf16 v[28:31], v[128:131], v[12:15], v[28:31]
    v_mfma_f32_16x16x32_bf16 v[32:35], v[132:135], v[12:15], v[32:35]
    v_and_b32 v12, v43, v4
    v_and_b32 v13, v43, v5
    v_and_b32 v14, v43, v6
    v_and_b32 v15, v43, v7
    v_mfma_f32_16x16x32_bf16 v[16:19], v[136:139], v[8:11], v[16:19]
    v_mfma_f32_16x16x32_bf16 v[20:23], v[140:143], v[8:11], v[20:23]
    v_mfma_f32_16x16x32_bf16 v[24:27], v[144:147], v[8:11], v[24:27]
    v_mfma_f32_16x16x32_bf16 v[28:31], v[148:151], v[8:11], v[28:31]
    v_mfma_f32_16x16x32_bf16 v[32:35], v[152:155], v[8:11], v[32:35]
    s_nop 1
    v_mfma_f32_16x16x32_bf16 v[16:19], v[156:159], v[12:15], v[16:19]
    v_mfma_f32_16x16x32_bf16 v[20:23], v[160:163], v[12:15], v[20:23]
    v_mfma_f32_16x16x32_bf16 v[24:27], v[164:167], v[12:15], v[24:27]
    v_mfma_f32_16x16x32_bf16 v[28:31], v[168:171], v[12:15], v[28:31]
    v_mfma_f32_16x16x32_bf16 v[32:35], v[172:175], v[12:15], v[32:35]
    s_mov_b32 exec_lo, 0x00ff00ff
    s_mov_b32 exec_hi, 0x00ff00ff
    s_nop 1
    ds_write_b128 v93, v[16:19] offset:0
    ds_write_b128 v93, v[20:23] offset:512
    ds_write_b128 v93, v[24:27] offset:1024
    ds_write_b128 v93, v[28:31] offset:1536
    ds_write_b128 v93, v[32:35] offset:2048
    s_mov_b64 exec, -1
    s_add_u32 s62, s62, 4
    v_mov_b32 v39, 12800
    v_mov_b32 v3, 1
    s_waitcnt lgkmcnt(0)
    s_mov_b64 exec, 1
    ds_add_u32 v39, v3
    s_mov_b64 exec, -1
L_sync_dn:
    ds_read_b32 v3, v39
    s_waitcnt lgkmcnt(0)
    v_readfirstlane_b32 s43, v3
    s_cmp_lt_u32 s43, s62
    s_cbranch_scc1 L_sync_dn
    s_cmp_ge_u32 s40, 3
    s_cbranch_scc1 L_out_dn
    ds_read_b128 v[16:19], v94 offset:30592
    ds_read_b128 v[20:23], v94 offset:33152
    ds_read_b128 v[24:27], v94 offset:35712
    ds_read_b128 v[28:31], v94 offset:38272
    v_lshrrev_b32 v39, 6, v94
    v_lshl_add_u32 v39, v39, 11, v95
    s_lshl_b32 s64, s41, 6
    s_add_u32 s64, s64, 655360
    s_waitcnt lgkmcnt(2)
    v_add_f32 v16, v16, v20
    v_add_f32 v17, v17, v21
    v_add_f32 v18, v18, v22
    v_add_f32 v19, v19, v23
    s_waitcnt lgkmcnt(0)
    v_add_f32 v24, v24, v28
    v_add_f32 v25, v25, v29
    v_add_f32 v26, v26, v30
    v_add_f32 v27, v27, v31
    v_add_f32 v16, v16, v24
    v_add_f32 v17, v17, v25
    v_add_f32 v18, v18, v26
    v_add_f32 v19, v19, v27
    s_mov_b64 exec, s[68:69]
    buffer_store_dwordx4 v[16:19], v39, s[36:39], s64 offen sc1
    s_mov_b64 exec, -1
L_out_dn:
L_noffn:
    s_mov_b32 s28, s12
    s_mov_b32 s29, s13
    s_mov_b32 s30, 5242880
    s_lshl_b32 s43, s41, 7
    s_lshl_b32 s45, s40, 5
    s_add_u32 s43, s43, s45
    v_lshl_add_u32 v3, v1, 3, s43
    v_mul_u32_u24 v36, 1280, v3
    v_lshl_add_u32 v36, v2, 4, v36
    s_mov_b32 s43, 0
    buffer_load_dwordx4 v[96:99], v36, s[28:31], s43 offen offset:0
    buffer_load_dwordx4 v[100:103], v36, s[28:31], s43 offen offset:256
    s_waitcnt vmcnt(1)
    buffer_load_dwordx4 v[104:107], v36, s[28:31], s43 offen offset:512
    s_waitcnt vmcnt(1)
    buffer_load_dwordx4 v[108:111], v36, s[28:31], s43 offen offset:768
    s_waitcnt vmcnt(1)
    buffer_load_dwordx4 v[112:115], v36, s[28:31], s43 offen offset:1024
    s_mov_b32 s43, 1280
    s_waitcnt vmcnt(1)
    buffer_load_dwordx4 v[116:119], v36, s[28:31], s43 offen offset:0
    s_waitcnt vmcnt(1)
    buffer_load_dwordx4 v[120:123], v36, s[28:31], s43 offen offset:256
    s_waitcnt vmcnt(1)
    buffer_load_dwordx4 v[124:127], v36, s[28:31], s43 offen offset:512
    s_waitcnt vmcnt(1)
    buffer_load_dwordx4 v[128:131], v36, s[28:31], s43 offen offset:768
    s_waitcnt vmcnt(1)
    buffer_load_dwordx4 v[132:135], v36, s[28:31], s43 offen offset:1024
    s_mov_b32 s43, 2560
    s_waitcnt vmcnt(1)
    buffer_load_dwordx4 v[136:139], v36, s[28:31], s43 offen offset:0
    s_waitcnt vmcnt(1)
    buffer_load_dwordx4 v[140:143], v36, s[28:31], s43 offen offset:256
    s_waitcnt vmcnt(1)
    buffer_load_dwordx4 v[144:147], v36, s[28:31], s43 offen offset:512
    s_waitcnt vmcnt(1)
    buffer_load_dwordx4 v[148:151], v36, s[28:31], s43 offen offset:768
    s_waitcnt vmcnt(1)
    buffer_load_dwordx4 v[152:155], v36, s[28:31], s43 offen offset:1024
    s_mov_b32 s43, 3840
    s_waitcnt vmcnt(1)
    buffer_load_dwordx4 v[156:159], v36, s[28:31], s43 offen offset:0
    s_waitcnt vmcnt(1)
    buffer_load_dwordx4 v[160:163], v36, s[28:31], s43 offen offset:256
    s_waitcnt vmcnt(1)
    buffer_load_dwordx4 v[164:167], v36, s[28:31], s43 offen offset:512
    s_waitcnt vmcnt(1)
    buffer_load_dwordx4 v[168:171], v36, s[28:31], s43 offen offset:768
    s_waitcnt vmcnt(1)
    buffer_load_dwordx4 v[172:175], v36, s[28:31], s43 offen offset:1024
    s_mov_b32 s43, 5120
    s_waitcnt vmcnt(1)
    buffer_load_dwordx4 v[176:179], v36, s[28:31], s43 offen offset:0
    s_waitcnt vmcnt(1)
    buffer_load_dwordx4 v[180:183], v36, s[28:31], s43 offen offset:256
    s_waitcnt vmcnt(1)
    buffer_load_dwordx4 v[184:187], v36, s[28:31], s43 offen offset:512
    s_waitcnt vmcnt(1)
    buffer_load_dwordx4 v[188:191], v36, s[28:31], s43 offen offset:768
    s_waitcnt vmcnt(1)
    buffer_load_dwordx4 v[192:195], v36, s[28:31], s43 offen offset:1024
    s_mov_b32 s43, 6400
    s_waitcnt vmcnt(1)
    buffer_load_dwordx4 v[196:199], v36, s[28:31], s43 offen offset:0
    s_waitcnt vmcnt(1)
    buffer_load_dwordx4 v[200:203], v36, s[28:31], s43 offen offset:256
    s_waitcnt vmcnt(1)
    buffer_load_dwordx4 v[204:207], v36, s[28:31], s43 offen offset:512
    s_waitcnt vmcnt(1)
    buffer_load_dwordx4 v[208:211], v36, s[28:31], s43 offen offset:768
    s_waitcnt vmcnt(1)
    buffer_load_dwordx4 v[212:215], v36, s[28:31], s43 offen offset:1024
    s_mov_b32 s43, 7680
    s_waitcnt vmcnt(1)
    buffer_load_dwordx4 v[216:219], v36, s[28:31], s43 offen offset:0
    s_waitcnt vmcnt(1)
    buffer_load_dwordx4 v[220:223], v36, s[28:31], s43 offen offset:256
    s_waitcnt vmcnt(1)
    buffer_load_dwordx4 v[224:227], v36, s[28:31], s43 offen offset:512
    s_waitcnt vmcnt(1)
    buffer_load_dwordx4 v[228:231], v36, s[28:31], s43 offen offset:768
    s_waitcnt vmcnt(1)
    buffer_load_dwordx4 v[232:235], v36, s[28:31], s43 offen offset:1024
    s_mov_b32 s43, 8960
    s_waitcnt vmcnt(1)
    buffer_load_dwordx4 v[236:239], v36, s[28:31], s43 offen offset:0
    s_waitcnt vmcnt(1)
    buffer_load_dwordx4 v[240:243], v36, s[28:31], s43 offen offset:256
    s_waitcnt vmcnt(1)
    buffer_load_dwordx4 v[244:247], v36, s[28:31], s43 offen offset:512
    s_waitcnt vmcnt(1)
    buffer_load_dwordx4 v[248:251], v36, s[28:31], s43 offen offset:768
    s_waitcnt vmcnt(1)
    buffer_load_dwordx4 v[252:255], v36, s[28:31], s43 offen offset:1024
    v_mov_b32 v39, 12800
L_wtr:
    s_sleep 8
    ds_read_b32 v3, v39 offset:4
    s_waitcnt lgkmcnt(0)
    v_readfirstlane_b32 s43, v3
    s_cmp_lt_u32 s43, 4
    s_cbranch_scc1 L_wtr
    ds_read_b128 v[80:83], v39 offset:16
    s_lshl_b32 s43, s40, 12
    v_add_u32 v88, s43, v88
    ds_read_b128 v[40:43], v88 offset:14208
    ds_read_b128 v[44:47], v88 offset:15232
    ds_read_b128 v[48:51], v88 offset:16256
    ds_read_b128 v[52:55], v88 offset:17280
    s_mov_b32 s61, 0x3fb8aa3b
    s_waitcnt lgkmcnt(0)
    v_max3_f32 v8, v80, v81, v82
    v_max_f32 v8, v8, v83
    v_mul_f32 v8, s61, v8
    v_fma_f32 v80, v80, s61, -v8
    v_exp_f32 v80, v80
    v_fma_f32 v81, v81, s61, -v8
    v_exp_f32 v81, v81
    v_fma_f32 v82, v82, s61, -v8
    v_exp_f32 v82, v82
    v_fma_f32 v83, v83, s61, -v8
    v_exp_f32 v83, v83
    v_fma_f32 v40, v40, s61, -v8
    v_exp_f32 v40, v40
    v_fma_f32 v41, v41, s61, -v8
    v_exp_f32 v41, v41
    v_fma_f32 v42, v42, s61, -v8
    v_exp_f32 v42, v42
    v_fma_f32 v43, v43, s61, -v8
    v_exp_f32 v43, v43
    v_fma_f32 v44, v44, s61, -v8
    v_exp_f32 v44, v44
    v_fma_f32 v45, v45, s61, -v8
    v_exp_f32 v45, v45
    v_fma_f32 v46, v46, s61, -v8
    v_exp_f32 v46, v46
    v_fma_f32 v47, v47, s61, -v8
    v_exp_f32 v47, v47
    v_fma_f32 v48, v48, s61, -v8
    v_exp_f32 v48, v48
    v_fma_f32 v49, v49, s61, -v8
    v_exp_f32 v49, v49
    v_fma_f32 v50, v50, s61, -v8
    v_exp_f32 v50, v50
    v_fma_f32 v51, v51, s61, -v8
    v_exp_f32 v51, v51
    v_fma_f32 v52, v52, s61, -v8
    v_exp_f32 v52, v52
    v_fma_f32 v53, v53, s61, -v8
    v_exp_f32 v53, v53
    v_fma_f32 v54, v54, s61, -v8
    v_exp_f32 v54, v54
    v_fma_f32 v55, v55, s61, -v8
    v_exp_f32 v55, v55
    s_nop 0
    v_add_f32 v9, v40, v41
    v_add_f32 v9, v9, v42
    v_add_f32 v9, v9, v43
    v_add_f32 v9, v9, v44
    v_add_f32 v9, v9, v45
    v_add_f32 v9, v9, v46
    v_add_f32 v9, v9, v47
    v_add_f32 v9, v9, v48
    v_add_f32 v9, v9, v49
    v_add_f32 v9, v9, v50
    v_add_f32 v9, v9, v51
    v_add_f32 v9, v9, v52
    v_add_f32 v9, v9, v53
    v_add_f32 v9, v9, v54
    v_add_f32 v9, v9, v55
    s_nop 1
    v_add_f32_dpp v9, v9, v9 quad_perm:[1,0,3,2] row_mask:0xf bank_mask:0xf
    s_nop 1
    v_add_f32_dpp v9, v9, v9 quad_perm:[2,3,0,1] row_mask:0xf bank_mask:0xf
    s_nop 1
    v_add_f32_dpp v9, v9, v9 row_half_mirror row_mask:0xf bank_mask:0xf
    s_nop 1
    v_add_f32_dpp v9, v9, v9 row_ror:8 row_mask:0xf bank_mask:0xf
    v_mov_b32 v10, v9
    s_nop 1
    v_permlane16_swap_b32 v10, v9
    v_add_f32 v9, v9, v10
    v_mov_b32 v10, v9
    s_nop 1
    v_permlane32_swap_b32 v10, v9
    v_add_f32 v9, v9, v10
    s_lshl_b32 s43, s40, 2
    s_add_u32 s43, s43, 12832
    v_mov_b32 v10, s43
    ds_write_b32 v10, v9
    s_waitcnt vmcnt(0)
    s_add_u32 s62, s62, 4
    v_mov_b32 v39, 12800
    v_mov_b32 v3, 1
    s_waitcnt lgkmcnt(0)
    s_mov_b64 exec, 1
    ds_add_u32 v39, v3
    s_mov_b64 exec, -1
L_sync_l:
    ds_read_b32 v3, v39
    s_waitcnt lgkmcnt(0)
    v_readfirstlane_b32 s43, v3
    s_cmp_lt_u32 s43, s62
    s_cbranch_scc1 L_sync_l
    s_cmp_lg_u32 s40, 0
    s_cbranch_scc1 L_noml
    ds_read_b128 v[12:15], v39 offset:32
    s_add_u32 s43, s63, 737280
    v_mov_b32 v10, s74
    v_mov_b32 v11, s75
    s_waitcnt lgkmcnt(0)
    v_add_f32 v12, v12, v13
    v_add_f32 v14, v14, v15
    v_add_f32 v9, v12, v14
    s_mov_b64 exec, 15
    buffer_store_dwordx4 v[8:11], v88, s[36:39], s43 offen sc1
    s_mov_b64 exec, -1
    s_nop 1
L_noml:
    s_lshr_b32 s46, s41, 2
    s_add_u32 s46, s46, 32
    s_and_b32 s43, s41, 3
    s_lshl_b32 s43, s43, 3
    s_add_u32 s43, s43, s42
    s_cmp_eq_u32 s43, 5
    s_cselect_b32 s46, s46, 99
    s_cmp_eq_u32 s42, 3
    s_cselect_b32 s46, s41, s46
    s_cmp_ge_u32 s46, 40
    s_cbranch_scc1 L_nofin1
    v_lshlrev_b32 v12, 2, v94
    s_mov_b32 s43, 737280
    s_mov_b32 s47, 1000000
L_rdy:
    s_sleep 100
    buffer_load_dwordx4 v[8:11], v12, s[36:39], s43 offen sc1
    s_sub_u32 s47, s47, 1
    s_cbranch_scc1 L_rdyx
    s_waitcnt vmcnt(0)
    v_cmp_ne_u64 vcc, s[74:75], v[10:11]
    s_and_b64 exec, exec, vcc
    s_cbranch_scc1 L_rdy
L_rdyx:
    s_mov_b64 exec, -1
    s_waitcnt vmcnt(0)
    v_mov_b32 v10, v8
    s_nop 1
    v_max_f32_dpp v10, v10, v10 quad_perm:[1,0,3,2] row_mask:0xf bank_mask:0xf
    s_nop 1
    v_max_f32_dpp v10, v10, v10 quad_perm:[2,3,0,1] row_mask:0xf bank_mask:0xf
    s_nop 1
    v_max_f32_dpp v10, v10, v10 row_half_mirror row_mask:0xf bank_mask:0xf
    v_sub_f32 v8, v8, v10
    v_exp_f32 v8, v8
    s_nop 0
    v_mul_f32 v9, v8, v9
    s_nop 1
    v_add_f32_dpp v9, v9, v9 quad_perm:[1,0,3,2] row_mask:0xf bank_mask:0xf
    s_nop 1
    v_add_f32_dpp v9, v9, v9 quad_perm:[2,3,0,1] row_mask:0xf bank_mask:0xf
    s_nop 1
    v_add_f32_dpp v9, v9, v9 row_half_mirror row_mask:0xf bank_mask:0xf
    v_rcp_f32 v9, v9
    s_nop 0
    v_mul_f32 v8, v8, v9
    v_and_b32 v10, 60, v0
    ds_bpermute_b32 v84, v10, v8 offset:0
    ds_bpermute_b32 v85, v10, v8 offset:64
    ds_bpermute_b32 v86, v10, v8 offset:128
    ds_bpermute_b32 v87, v10, v8 offset:192
    s_add_u32 s62, s62, 4
    v_mov_b32 v39, 12800
    v_mov_b32 v3, 1
    s_waitcnt lgkmcnt(0)
    s_mov_b64 exec, 1
    ds_add_u32 v39, v3
    s_mov_b64 exec, -1
L_sync_ml:
    ds_read_b32 v3, v39
    s_waitcnt lgkmcnt(0)
    v_readfirstlane_b32 s43, v3
    s_cmp_lt_u32 s43, s62
    s_cbranch_scc1 L_sync_ml
    s_cmp_lg_u32 s40, 0
    s_cbranch_scc1 L_nofin1
    s_lshl_b32 s43, s46, 11
    s_add_u32 s43, s43, 655360
    v_mov_b32 v16, 0
    v_mov_b32 v17, 0
    v_mov_b32 v18, 0
    v_mov_b32 v19, 0
    buffer_load_dwordx4 v[12:15], v88, s[36:39], s43 offen sc1
    s_mov_b32 exec_lo, -1
    s_mov_b32 exec_hi, 0xfff
    buffer_load_dwordx4 v[16:19], v88, s[36:39], s43 offen offset:1024 sc1
    s_mov_b64 exec, -1
    v_bfe_u32 v20, v0, 2, 2
    s_lshl_b32 s43, s46, 2
    v_add_u32 v20, s43, v20
    v_and_b32 v91, 7, v20
    v_lshrrev_b32 v20, 3, v20
    v_lshl_add_u32 v91, v20, 5, v91
    v_and_b32 v20, 3, v0
    v_lshl_add_u32 v91, v20, 3, v91
    v_lshlrev_b32 v91, 1, v91
    buffer_load_ushort v90, v91, s[32:35], 0 offen
    s_waitcnt vmcnt(1)
    v_add_f32 v12, v12, v16
    v_add_f32 v13, v13, v17
    v_add_f32 v14, v14, v18
    v_add_f32 v15, v15, v19
    s_nop 1
    v_add_f32_dpp v12, v12, v12 row_ror:4 row_mask:0xf bank_mask:0xf
    v_add_f32_dpp v13, v13, v13 row_ror:4 row_mask:0xf bank_mask:0xf
    v_add_f32_dpp v14, v14, v14 row_ror:4 row_mask:0xf bank_mask:0xf
    v_add_f32_dpp v15, v15, v15 row_ror:4 row_mask:0xf bank_mask:0xf
    s_nop 1
    v_add_f32_dpp v12, v12, v12 row_ror:8 row_mask:0xf bank_mask:0xf
    v_add_f32_dpp v13, v13, v13 row_ror:8 row_mask:0xf bank_mask:0xf
    v_add_f32_dpp v14, v14, v14 row_ror:8 row_mask:0xf bank_mask:0xf
    v_add_f32_dpp v15, v15, v15 row_ror:8 row_mask:0xf bank_mask:0xf
    v_lshlrev_b32 v10, 6, v1
    v_add_u32 v10, v10, v95
    s_mov_b32 exec_lo, 0x000f000f
    s_mov_b32 exec_hi, 0x000f000f
    ds_write_b128 v10, v[12:15] offset:13952
    s_mov_b64 exec, -1
    v_lshlrev_b32 v10, 2, v2
    v_add_u32 v10, 13952, v10
    ds_read2_b32 v[12:13], v10 offset0:0 offset1:16
    ds_read2_b32 v[14:15], v10 offset0:32 offset1:48
    s_waitcnt lgkmcnt(0)
    v_add_f32 v12, v12, v13
    v_add_f32 v14, v14, v15
    v_add_f32 v12, v12, v14
    v_cvt_pk_bf16_f32 v12, v12, v12
    v_and_b32 v12, 0xffff0000, v12
    v_mul_f32 v13, 0xbfb8aa3b, v12
    v_exp_f32 v13, v13
    s_nop 0
    v_add_f32 v13, 1.0, v13
    v_rcp_f32 v13, v13
    s_nop 0
    v_mul_f32 v12, v12, v13
    v_cvt_pk_bf16_f32 v89, v12, v12
    v_and_b32 v89, 0xffff0000, v89
    s_waitcnt vmcnt(0)
    v_lshlrev_b32 v90, 16, v90
    s_mov_b32 s32, s22
    s_mov_b32 s33, s23
L_nofin1:
    s_lshl_b32 s43, s40, 7
    v_lshl_add_u32 v37, v1, 5, s43
    s_lshl_b32 s64, s46, 14
    s_mov_b64 s[52:53], -1
    s_mov_b64 s[54:55], -1
    s_mov_b64 s[56:57], -1
    s_mov_b64 s[58:59], -1
    v_lshlrev_b32 v38, 6, v1
    v_add_u32 v38, v38, v95
    s_lshl_b32 s43, s40, 8
    s_add_u32 s43, s43, 12928
    v_add_u32 v38, s43, v38
    v_lshlrev_b32 v39, 8, v1
    v_lshl_add_u32 v39, v2, 2, v39
    v_add_u32 v39, 12928, v39
    s_mov_b32 s47, 1000000
    s_waitcnt vmcnt(0)
    s_barrier
    ds_read_b128 v[48:51], v37 offset:10752
    ds_read_b128 v[56:59], v37 offset:11264
    ds_read_b128 v[64:67], v37 offset:11776
    ds_read_b128 v[72:75], v37 offset:12288
    ds_read_b128 v[52:55], v37 offset:10768
    ds_read_b128 v[60:63], v37 offset:11280
    ds_read_b128 v[68:71], v37 offset:11792
    ds_read_b128 v[76:79], v37 offset:12304
    s_waitcnt lgkmcnt(4)
    v_mul_f32 v48, v80, v48
    v_fmac_f32 v48, v81, v56
    v_fmac_f32 v48, v82, v64
    v_fmac_f32 v48, v83, v72
    v_cvt_pk_bf16_f32 v48, v48, v48
    v_and_b32 v8, v48, v4
    v_and_b32 v9, v48, v5
    v_and_b32 v10, v48, v6
    v_and_b32 v11, v48, v7
    v_mul_f32 v49, v80, v49
    v_fmac_f32 v49, v81, v57
    v_fmac_f32 v49, v82, v65
    v_fmac_f32 v49, v83, v73
    v_cvt_pk_bf16_f32 v49, v49, v49
    v_and_b32 v12, v49, v4
    v_and_b32 v13, v49, v5
    v_and_b32 v14, v49, v6
    v_and_b32 v15, v49, v7
    v_mfma_f32_16x16x32_bf16 v[16:19], v[96:99], v[8:11], 0
    v_mul_f32 v50, v80, v50
    v_fmac_f32 v50, v81, v58
    v_mfma_f32_16x16x32_bf16 v[20:23], v[100:103], v[8:11], 0
    v_fmac_f32 v50, v82, v66
    v_fmac_f32 v50, v83, v74
    v_mfma_f32_16x16x32_bf16 v[24:27], v[104:107], v[8:11], 0
    v_cvt_pk_bf16_f32 v50, v50, v50
    v_and_b32 v40, v50, v4
    v_mfma_f32_16x16x32_bf16 v[28:31], v[108:111], v[8:11], 0
    v_and_b32 v41, v50, v5
    v_and_b32 v42, v50, v6
    v_mfma_f32_16x16x32_bf16 v[32:35], v[112:115], v[8:11], 0
    v_and_b32 v43, v50, v7
    v_mfma_f32_16x16x32_bf16 v[16:19], v[116:119], v[12:15], v[16:19]
    v_mul_f32 v51, v80, v51
    v_fmac_f32 v51, v81, v59
    v_mfma_f32_16x16x32_bf16 v[20:23], v[120:123], v[12:15], v[20:23]
    v_fmac_f32 v51, v82, v67
    v_fmac_f32 v51, v83, v75
    v_mfma_f32_16x16x32_bf16 v[24:27], v[124:127], v[12:15], v[24:27]
    v_cvt_pk_bf16_f32 v51, v51, v51
    v_and_b32 v44, v51, v4
    v_mfma_f32_16x16x32_bf16 v[28:31], v[128:131], v[12:15], v[28:31]
    v_and_b32 v45, v51, v5
    v_and_b32 v46, v51, v6
    v_mfma_f32_16x16x32_bf16 v[32:35], v[132:135], v[12:15], v[32:35]
    v_and_b32 v47, v51, v7
    s_waitcnt lgkmcnt(0)
    v_mfma_f32_16x16x32_bf16 v[16:19], v[136:139], v[40:43], v[16:19]
    v_mul_f32 v52, v80, v52
    v_fmac_f32 v52, v81, v60
    v_mfma_f32_16x16x32_bf16 v[20:23], v[140:143], v[40:43], v[20:23]
    v_fmac_f32 v52, v82, v68
    v_fmac_f32 v52, v83, v76
    v_mfma_f32_16x16x32_bf16 v[24:27], v[144:147], v[40:43], v[24:27]
    v_cvt_pk_bf16_f32 v52, v52, v52
    v_and_b32 v8, v52, v4
    v_mfma_f32_16x16x32_bf16 v[28:31], v[148:151], v[40:43], v[28:31]
    v_and_b32 v9, v52, v5
    v_and_b32 v10, v52, v6
    v_mfma_f32_16x16x32_bf16 v[32:35], v[152:155], v[40:43], v[32:35]
    v_and_b32 v11, v52, v7
    v_mfma_f32_16x16x32_bf16 v[16:19], v[156:159], v[44:47], v[16:19]
    v_mul_f32 v53, v80, v53
    v_fmac_f32 v53, v81, v61
    v_mfma_f32_16x16x32_bf16 v[20:23], v[160:163], v[44:47], v[20:23]
    v_fmac_f32 v53, v82, v69
    v_fmac_f32 v53, v83, v77
    v_mfma_f32_16x16x32_bf16 v[24:27], v[164:167], v[44:47], v[24:27]
    v_cvt_pk_bf16_f32 v53, v53, v53
    v_and_b32 v12, v53, v4
    v_mfma_f32_16x16x32_bf16 v[28:31], v[168:171], v[44:47], v[28:31]
    v_and_b32 v13, v53, v5
    v_and_b32 v14, v53, v6
    v_mfma_f32_16x16x32_bf16 v[32:35], v[172:175], v[44:47], v[32:35]
    v_and_b32 v15, v53, v7
    v_mfma_f32_16x16x32_bf16 v[16:19], v[176:179], v[8:11], v[16:19]
    v_mul_f32 v54, v80, v54
    v_fmac_f32 v54, v81, v62
    v_mfma_f32_16x16x32_bf16 v[20:23], v[180:183], v[8:11], v[20:23]
    v_fmac_f32 v54, v82, v70
    v_fmac_f32 v54, v83, v78
    v_mfma_f32_16x16x32_bf16 v[24:27], v[184:187], v[8:11], v[24:27]
    v_cvt_pk_bf16_f32 v54, v54, v54
    v_and_b32 v40, v54, v4
    v_mfma_f32_16x16x32_bf16 v[28:31], v[188:191], v[8:11], v[28:31]
    v_and_b32 v41, v54, v5
    v_and_b32 v42, v54, v6
    v_mfma_f32_16x16x32_bf16 v[32:35], v[192:195], v[8:11], v[32:35]
    v_and_b32 v43, v54, v7
    v_mfma_f32_16x16x32_bf16 v[16:19], v[196:199], v[12:15], v[16:19]
    v_mul_f32 v55, v80, v55
    v_fmac_f32 v55, v81, v63
    v_mfma_f32_16x16x32_bf16 v[20:23], v[200:203], v[12:15], v[20:23]
    v_fmac_f32 v55, v82, v71
    v_fmac_f32 v55, v83, v79
    v_mfma_f32_16x16x32_bf16 v[24:27], v[204:207], v[12:15], v[24:27]
    v_cvt_pk_bf16_f32 v55, v55, v55
    v_and_b32 v44, v55, v4
    v_mfma_f32_16x16x32_bf16 v[28:31], v[208:211], v[12:15], v[28:31]
    v_and_b32 v45, v55, v5
    v_and_b32 v46, v55, v6
    v_mfma_f32_16x16x32_bf16 v[32:35], v[212:215], v[12:15], v[32:35]
    v_and_b32 v47, v55, v7
    s_nop 0
    v_mfma_f32_16x16x32_bf16 v[16:19], v[216:219], v[40:43], v[16:19]
    v_mfma_f32_16x16x32_bf16 v[16:19], v[236:239], v[44:47], v[16:19]
    v_mfma_f32_16x16x32_bf16 v[20:23], v[220:223], v[40:43], v[20:23]
    v_mfma_f32_16x16x32_bf16 v[20:23], v[240:243], v[44:47], v[20:23]
    v_mfma_f32_16x16x32_bf16 v[24:27], v[224:227], v[40:43], v[24:27]
    v_mfma_f32_16x16x32_bf16 v[24:27], v[244:247], v[44:47], v[24:27]
    s_nop 3
    ds_write_b128 v93, v[16:19] offset:0
    v_mfma_f32_16x16x32_bf16 v[28:31], v[228:231], v[40:43], v[28:31]
    v_mfma_f32_16x16x32_bf16 v[28:31], v[248:251], v[44:47], v[28:31]
    ds_write_b128 v93, v[20:23] offset:512
    v_mfma_f32_16x16x32_bf16 v[32:35], v[232:235], v[40:43], v[32:35]
    v_mfma_f32_16x16x32_bf16 v[32:35], v[252:255], v[44:47], v[32:35]
    ds_write_b128 v93, v[24:27] offset:1024
    s_mov_b32 exec_lo, 0x00ff00ff
    s_mov_b32 exec_hi, 0x00ff00ff
    s_nop 1
    ds_write_b128 v93, v[28:31] offset:1536
    s_nop 1
    ds_write_b128 v93, v[32:35] offset:2048
    s_mov_b64 exec, -1
    s_waitcnt lgkmcnt(0)
    s_barrier
    s_cmp_ge_u32 s40, 3
    s_cbranch_scc1 L_out_wo
    ds_read_b128 v[16:19], v94 offset:30592
    ds_read_b128 v[20:23], v94 offset:33152
    ds_read_b128 v[24:27], v94 offset:35712
    ds_read_b128 v[28:31], v94 offset:38272
    s_waitcnt lgkmcnt(2)
    v_add_f32 v16, v16, v20
    v_add_f32 v17, v17, v21
    v_add_f32 v18, v18, v22
    v_add_f32 v19, v19, v23
    s_waitcnt lgkmcnt(0)
    v_add_f32 v24, v24, v28
    v_add_f32 v25, v25, v29
    v_add_f32 v26, v26, v30
    v_add_f32 v27, v27, v31
    v_add_f32 v16, v16, v24
    v_add_f32 v17, v17, v25
    v_add_f32 v18, v18, v26
    v_add_f32 v19, v19, v27
    v_min_u32 v16, -2, v16
    v_min_u32 v17, -2, v17
    v_min_u32 v18, -2, v18
    v_min_u32 v19, -2, v19
    s_mov_b64 exec, s[68:69]
    buffer_store_dwordx4 v[16:19], v92, s[36:39], s63 offen sc1
    s_mov_b64 exec, -1
L_out_wo:
    s_cmp_ge_u32 s46, 40
    s_cbranch_scc1 L_nofin2
    s_waitcnt vmcnt(0)
L_poll:
    s_sub_u32 s47, s47, 1
    s_cbranch_scc1 L_pollx
    s_mov_b64 exec, s[52:53]
    s_cbranch_execz L_pk0
    buffer_load_dwordx4 v[40:43], v88, s[36:39], s64 offen offset:0 sc1
L_pk0:
    s_mov_b64 exec, s[54:55]
    s_cbranch_execz L_pk1
    buffer_load_dwordx4 v[44:47], v88, s[36:39], s64 offen offset:1024 sc1
L_pk1:
    s_mov_b64 exec, s[56:57]
    s_cbranch_execz L_pk2
    buffer_load_dwordx4 v[48:51], v88, s[36:39], s64 offen offset:2048 sc1
L_pk2:
    s_mov_b64 exec, s[58:59]
    s_cbranch_execz L_pk3
    buffer_load_dwordx4 v[52:55], v88, s[36:39], s64 offen offset:3072 sc1
L_pk3:
    s_mov_b64 exec, -1
    s_waitcnt vmcnt(0)
    v_max3_u32 v12, v40, v41, v42
    v_max3_u32 v13, v44, v45, v46
    v_max3_u32 v14, v48, v49, v50
    v_max3_u32 v15, v52, v53, v54
    v_max_u32 v12, v12, v43
    v_max_u32 v13, v13, v47
    v_max_u32 v14, v14, v51
    v_max_u32 v15, v15, v55
    v_cmp_eq_u32_e64 s[52:53], -1, v12
    v_cmp_eq_u32_e64 s[54:55], -1, v13
    v_cmp_eq_u32_e64 s[56:57], -1, v14
    v_cmp_eq_u32_e64 s[58:59], -1, v15
    s_or_b64 s[60:61], s[52:53], s[54:55]
    s_or_b64 s[66:67], s[56:57], s[58:59]
    s_or_b64 s[60:61], s[60:61], s[66:67]
    s_cbranch_scc1 L_poll
L_pollx:
    v_mul_f32 v12, v84, v40
    v_mul_f32 v13, v84, v41
    v_mul_f32 v14, v84, v42
    v_mul_f32 v15, v84, v43
    v_fmac_f32 v12, v85, v44
    v_fmac_f32 v13, v85, v45
    v_fmac_f32 v14, v85, v46
    v_fmac_f32 v15, v85, v47
    v_fmac_f32 v12, v86, v48
    v_fmac_f32 v13, v86, v49
    v_fmac_f32 v14, v86, v50
    v_fmac_f32 v15, v86, v51
    v_fmac_f32 v12, v87, v52
    v_fmac_f32 v13, v87, v53
    v_fmac_f32 v14, v87, v54
    v_fmac_f32 v15, v87, v55
    v_add_f32_dpp v12, v12, v12 row_ror:4 row_mask:0xf bank_mask:0xf
    v_add_f32_dpp v13, v13, v13 row_ror:4 row_mask:0xf bank_mask:0xf
    v_add_f32_dpp v14, v14, v14 row_ror:4 row_mask:0xf bank_mask:0xf
    v_add_f32_dpp v15, v15, v15 row_ror:4 row_mask:0xf bank_mask:0xf
    v_add_f32_dpp v12, v12, v12 row_ror:8 row_mask:0xf bank_mask:0xf
    v_add_f32_dpp v13, v13, v13 row_ror:8 row_mask:0xf bank_mask:0xf
    v_add_f32_dpp v14, v14, v14 row_ror:8 row_mask:0xf bank_mask:0xf
    v_add_f32_dpp v15, v15, v15 row_ror:8 row_mask:0xf bank_mask:0xf
    s_mov_b32 exec_lo, 0x000f000f
    s_mov_b32 exec_hi, 0x000f000f
    ds_write_b128 v38, v[12:15]
    s_mov_b64 exec, -1
    s_waitcnt lgkmcnt(0)
    s_barrier
    s_cmp_lg_u32 s40, 0
    s_cbranch_scc1 L_nofin2
    ds_read2_b32 v[12:13], v39 offset0:0 offset1:16
    ds_read2_b32 v[14:15], v39 offset0:32 offset1:48
    s_waitcnt lgkmcnt(0)
    v_add_f32 v12, v12, v13
    v_add_f32 v14, v14, v15
    v_add_f32 v12, v12, v14
    v_mov_b32 v13, v12
    s_nop 1
    v_permlane16_swap_b32 v13, v12
    v_add_f32 v12, v12, v13
    v_mov_b32 v13, v12
    s_nop 1
    v_permlane32_swap_b32 v13, v12
    v_add_f32 v12, v12, v13
    v_cvt_pk_bf16_f32 v12, v12, v12
    v_and_b32 v12, 0xffff0000, v12
    v_mul_f32 v12, v12, v89
    v_cvt_pk_bf16_f32 v12, v12, v12
    v_and_b32 v12, 0xffff0000, v12
    v_add_f32 v12, v90, v12
    v_cvt_pk_bf16_f32 v12, v12, v12
    s_mov_b64 exec, 0xffff
    buffer_store_short v12, v91, s[32:35], 0 offen
    s_cmp_lg_u32 s46, 0
    s_cbranch_scc1 L_noep
    s_mov_b64 exec, 1
    v_mov_b32 v14, s74
    v_mov_b32 v15, s75
    v_mov_b32 v13, 1277952
    buffer_store_dwordx2 v[14:15], v13, s[36:39], 0 offen
L_noep:
    s_mov_b64 exec, -1
L_nofin2:
L_done:
    s_endpgm
.section .rodata,"a"
.p2align 6
.amdhsa_kernel recurrent_scan__mha_block_cached__glu_gated_reglu__decode_kernel
  .amdhsa_next_free_vgpr 256
  .amdhsa_next_free_sgpr 96
  .amdhsa_accum_offset 256
  .amdhsa_group_segment_fixed_size 0
  .amdhsa_kernarg_size 96
  .amdhsa_user_sgpr_count 2
  .amdhsa_user_sgpr_kernarg_segment_ptr 1
  .amdhsa_system_sgpr_workgroup_id_x 1
  .amdhsa_float_denorm_mode_32 3
.end_amdhsa_kernel
```
